```python
import torch

def _softmax(x, axis=-1):
    return torch.softmax(x, dim=axis)
def _gelu(x):
    return torch.nn.functional.gelu(x, approximate="tanh")
def _silu(x):
    return torch.nn.functional.silu(x)
def _sigmoid(x):
    return torch.sigmoid(x)
def _layernorm(x, axis=-1, eps=1e-5):
    m = x.mean(dim=axis, keepdim=True)
    v = x.var(dim=axis, keepdim=True, unbiased=False)
    return (x - m) / torch.sqrt(v + eps)
def _scatter_add(tgt, idx, src, axis=0):
    return tgt.clone().index_add_(axis, idx, src)
def _segment_sum(src, seg, n):
    out = torch.zeros((n,) + src.shape[1:], dtype=src.dtype)
    return out.index_add_(0, seg, src)
def _pad(x, pw):
    flat = tuple(v for pair in reversed(pw) for v in pair)
    return torch.nn.functional.pad(x, flat)

kernel_name = 'concat_heads__grouped_kv_mqa__compressed_kv_cla__prompt'

def setup_inputs():

    _w = (lambda a: (lambda t: t.to(torch.bfloat16) if t.is_floating_point() else t)(torch.as_tensor(a)))
    def _A_setup():
        B, S, D, H = 1, 2048, 512, 32
        Dh = D // H
        return {
            "x": _w((lambda *s: torch.randn(*s, dtype=torch.bfloat16) * 0.05)(B, S, D)),
            "wq": _w((lambda *s: torch.randn(*s, dtype=torch.bfloat16) * 0.8)(D, H * Dh)),
            "wk": _w((lambda *s: torch.randn(*s, dtype=torch.bfloat16) * 0.8)(D, Dh)),
            "wv": _w((lambda *s: torch.randn(*s, dtype=torch.bfloat16) * 0.05)(D, Dh)),
            "wo": _w((lambda *s: torch.randn(*s, dtype=torch.bfloat16) * 0.05)(H * Dh, D)),
        }
    _A_in = _A_setup()

    def _B_setup():
        B, H, Sq, Sk, D, M = 1, 32, 2048, 2048, 128, 512
        Dc = 4 * D
        return {
            "x": _w((lambda *s: torch.randn(*s, dtype=torch.bfloat16) * 3.2)(B, Sq, M)),
            "c_kv": _w((lambda *s: torch.randn(*s, dtype=torch.bfloat16) * 0.1)(B, Sk, Dc)),
            "w_q": _w((lambda *s: torch.randn(*s, dtype=torch.bfloat16) * 6.4)(M, H, D) * (M ** -0.5)),
            "w_uk": _w((lambda *s: torch.randn(*s, dtype=torch.bfloat16) * 6.4)(Dc, H, D) * (Dc ** -0.5)),
            "w_uv": _w((lambda *s: torch.randn(*s, dtype=torch.bfloat16) * 0.1)(Dc, H, D) * (Dc ** -0.5)),
            "w_o": _w((lambda *s: torch.randn(*s, dtype=torch.bfloat16) * 0.1)(H, D, M) * ((H * D) ** -0.5)),
        }
    _B_in = _B_setup()

    return {
        "A_x": _A_in["x"],
        "A_wq": _A_in["wq"],
        "A_wk": _A_in["wk"],
        "A_wv": _A_in["wv"],
        "A_wo": _A_in["wo"],
        "B_x": _B_in["x"],
        "B_c_kv": _B_in["c_kv"],
        "B_w_q": _B_in["w_q"],
        "B_w_uk": _B_in["w_uk"],
        "B_w_uv": _B_in["w_uv"],
        "B_w_o": _B_in["w_o"],
    }

def reference(A_x, A_wq, A_wk, A_wv, A_wo, B_x, B_c_kv, B_w_q, B_w_uk, B_w_uv, B_w_o):
    def _A_ref(x, wq, wk, wv, wo):
        B, S, D = x.shape
        H = 32
        Dh = D // H
        q = (lambda x, *d: x.permute(*d))((x @ wq).reshape(B, S, H, Dh), 0, 2, 1, 3)
        k = x @ wk
        v = x @ wv
        scores = torch.einsum("bhqd,bkd->bhqk", q, k) * (Dh ** -0.5)
        p = _softmax(scores, axis=-1)
        o = torch.einsum("bhqk,bkd->bhqd", p, v)
        return (lambda x, *d: x.permute(*d))(o, 0, 2, 1, 3).reshape(B, S, H * Dh) @ wo

    def _B_ref(x, c_kv, w_q, w_uk, w_uv, w_o):
        B, Sq, M = x.shape[0], x.shape[1], x.shape[2]
        Sk = c_kv.shape[1]
        H, D = w_q.shape[1], w_q.shape[2]
        q = torch.einsum("bqm,mhd->bhqd", x, w_q)
        k = torch.einsum("bkc,chd->bhkd", c_kv, w_uk)
        v = torch.einsum("bkc,chd->bhkd", c_kv, w_uv)
        scores = torch.einsum("bhqd,bhkd->bhqk", q, k) * (D ** -0.5)
        off = Sk - Sq
        qi = torch.arange(Sq)[:, None]
        kj = torch.arange(Sk)[None, :]
        cmask = kj <= (qi + off)
        scores = torch.where(cmask[None, None], scores, -1e9)
        p = _softmax(scores, axis=-1)
        ctx = torch.einsum("bhqk,bhkd->bhqd", p, v)
        return torch.einsum("bhqd,hdm->bqm", ctx, w_o)

    a = _A_ref(A_x, A_wq, A_wk, A_wv, A_wo)
    b = _B_ref(B_x, B_c_kv, B_w_q, B_w_uk, B_w_uv, B_w_o)
    return torch.concatenate([a, b], axis=-1)
```

```asm
; @launch kernel=proj_kernel grid=(416,1,1) block=(512,1,1) lds=147456
; @launch kernel=attnb_kernel grid=(1024,1,1) block=(256,1,1) lds=75776
; @launch kernel=outp_kernel grid=(1024,1,1) block=(128,1,1) lds=66560
.amdgcn_target "amdgcn-amd-amdhsa--gfx950"
.text
.globl proj_kernel
.p2align 8
.type proj_kernel,@function
proj_kernel:
    s_load_dwordx2 s[4:5], s[0:1], 104
    s_load_dwordx2 s[6:7], s[0:1], 88
    s_cmp_ge_u32 s2, 416
    s_cbranch_scc1 done_1002
    s_cmp_lt_u32 s2, 128
    s_cbranch_scc1 job_1003
    s_cmp_lt_u32 s2, 256
    s_cbranch_scc1 job_1004
    s_cmp_lt_u32 s2, 384
    s_cbranch_scc1 job_1005
    s_cmp_lt_u32 s2, 400
    s_cbranch_scc1 job_1006
    s_cmp_lt_u32 s2, 408
    s_cbranch_scc1 job_1007
    s_cmp_lt_u32 s2, 416
    s_cbranch_scc1 job_1008
job_1003:
    s_load_dwordx2 s[8:9], s[0:1], 40
    s_load_dwordx2 s[12:13], s[0:1], 56
    s_waitcnt lgkmcnt(0)
    s_add_u32 s8, s8, 0
    s_addc_u32 s9, s9, 0
    s_mov_b32 s10, 2097152
    s_mov_b32 s11, 0x00020000
    s_add_u32 s12, s12, 0
    s_addc_u32 s13, s13, 0
    s_mov_b32 s14, 4194304
    s_mov_b32 s15, 0x00020000
    s_add_u32 s16, s4, 0
    s_addc_u32 s17, s5, 0
    s_mov_b32 s18, 16777216
    s_mov_b32 s19, 0x00020000
    s_sub_u32 s20, s2, 0
    s_and_b32 s21, s20, 15
    s_lshr_b32 s22, s20, 4
    s_mov_b32 s23, 1024
    s_mov_b32 s24, 8192
    s_mov_b32 s25, 8192
    s_mov_b32 s26, 8
    s_mov_b32 s27, 4096
    s_branch body_1001
job_1004:
    s_load_dwordx2 s[8:9], s[0:1], 48
    s_load_dwordx2 s[12:13], s[0:1], 64
    s_waitcnt lgkmcnt(0)
    s_add_u32 s8, s8, 0
    s_addc_u32 s9, s9, 0
    s_mov_b32 s10, 2097152
    s_mov_b32 s11, 0x00020000
    s_add_u32 s12, s12, 0
    s_addc_u32 s13, s13, 0
    s_mov_b32 s14, 4194304
    s_mov_b32 s15, 0x00020000
    s_add_u32 s16, s4, 16777216
    s_addc_u32 s17, s5, 0
    s_mov_b32 s18, 16777216
    s_mov_b32 s19, 0x00020000
    s_sub_u32 s20, s2, 128
    s_and_b32 s21, s20, 15
    s_lshr_b32 s22, s20, 4
    s_mov_b32 s23, 1024
    s_mov_b32 s24, 8192
    s_mov_b32 s25, 8192
    s_mov_b32 s26, 8
    s_mov_b32 s27, 4096
    s_branch body_1001
job_1005:
    s_load_dwordx2 s[8:9], s[0:1], 48
    s_load_dwordx2 s[12:13], s[0:1], 72
    s_waitcnt lgkmcnt(0)
    s_add_u32 s8, s8, 0
    s_addc_u32 s9, s9, 0
    s_mov_b32 s10, 2097152
    s_mov_b32 s11, 0x00020000
    s_add_u32 s12, s12, 0
    s_addc_u32 s13, s13, 0
    s_mov_b32 s14, 4194304
    s_mov_b32 s15, 0x00020000
    s_add_u32 s16, s4, 33554432
    s_addc_u32 s17, s5, 0
    s_mov_b32 s18, 16777216
    s_mov_b32 s19, 0x00020000
    s_sub_u32 s20, s2, 256
    s_and_b32 s21, s20, 15
    s_lshr_b32 s22, s20, 4
    s_mov_b32 s23, 1024
    s_mov_b32 s24, 8192
    s_mov_b32 s25, 8192
    s_mov_b32 s26, 8
    s_mov_b32 s27, 4096
    s_branch body_1001
job_1006:
    s_load_dwordx2 s[8:9], s[0:1], 0
    s_load_dwordx2 s[12:13], s[0:1], 8
    s_waitcnt lgkmcnt(0)
    s_add_u32 s8, s8, 0
    s_addc_u32 s9, s9, 0
    s_mov_b32 s10, 2097152
    s_mov_b32 s11, 0x00020000
    s_add_u32 s12, s12, 0
    s_addc_u32 s13, s13, 0
    s_mov_b32 s14, 524288
    s_mov_b32 s15, 0x00020000
    s_add_u32 s16, s4, 50331648
    s_addc_u32 s17, s5, 0
    s_mov_b32 s18, 2097152
    s_mov_b32 s19, 0x00020000
    s_sub_u32 s20, s2, 384
    s_and_b32 s21, s20, 1
    s_lshr_b32 s22, s20, 1
    s_mov_b32 s23, 1024
    s_mov_b32 s24, 1024
    s_mov_b32 s25, 1024
    s_mov_b32 s26, 8
    s_mov_b32 s27, 512
    s_branch body_1001
job_1007:
    s_load_dwordx2 s[8:9], s[0:1], 0
    s_load_dwordx2 s[12:13], s[0:1], 16
    s_waitcnt lgkmcnt(0)
    s_add_u32 s8, s8, 0
    s_addc_u32 s9, s9, 0
    s_mov_b32 s10, 2097152
    s_mov_b32 s11, 0x00020000
    s_add_u32 s12, s12, 0
    s_addc_u32 s13, s13, 0
    s_mov_b32 s14, 16384
    s_mov_b32 s15, 0x00020000
    s_add_u32 s16, s4, 52428800
    s_addc_u32 s17, s5, 0
    s_mov_b32 s18, 65536
    s_mov_b32 s19, 0x00020000
    s_sub_u32 s20, s2, 400
    s_and_b32 s21, s20, 0
    s_lshr_b32 s22, s20, 0
    s_mov_b32 s23, 1024
    s_mov_b32 s24, 32
    s_mov_b32 s25, 32
    s_mov_b32 s26, 8
    s_mov_b32 s27, 16
    s_branch body_1001
job_1008:
    s_load_dwordx2 s[8:9], s[0:1], 0
    s_load_dwordx2 s[12:13], s[0:1], 24
    s_waitcnt lgkmcnt(0)
    s_add_u32 s8, s8, 0
    s_addc_u32 s9, s9, 0
    s_mov_b32 s10, 2097152
    s_mov_b32 s11, 0x00020000
    s_add_u32 s12, s12, 0
    s_addc_u32 s13, s13, 0
    s_mov_b32 s14, 16384
    s_mov_b32 s15, 0x00020000
    s_add_u32 s16, s4, 53477376
    s_addc_u32 s17, s5, 0
    s_mov_b32 s18, 65536
    s_mov_b32 s19, 0x00020000
    s_sub_u32 s20, s2, 408
    s_and_b32 s21, s20, 0
    s_lshr_b32 s22, s20, 0
    s_mov_b32 s23, 1024
    s_mov_b32 s24, 32
    s_mov_b32 s25, 32
    s_mov_b32 s26, 8
    s_mov_b32 s27, 16
    s_branch body_1001
body_1001:
    s_mul_i32 s21, s21, 256
    s_mul_i32 s22, s22, 256
    v_and_b32 v14, 7, v0
    v_lshrrev_b32 v15, 3, v0
    v_add_u32 v16, s22, v15
    v_mul_lo_u32 v16, v16, s23
    v_lshl_add_u32 v1, v14, 4, v16
    s_mul_i32 s28, s23, 64
    v_add_u32 v2, s28, v1
    v_add_u32 v3, s28, v2
    v_add_u32 v4, s28, v3
    s_movk_i32 s28, 144
    v_mul_lo_u32 v9, v15, s28
    v_lshl_add_u32 v9, v14, 4, v9
    v_and_b32 v14, 31, v0
    v_lshrrev_b32 v15, 5, v0
    v_mul_lo_u32 v16, v15, s24
    v_lshl_add_u32 v5, v14, 4, v16
    s_lshl_b32 s28, s21, 1
    v_add_u32 v5, s28, v5
    s_mul_i32 s28, s24, 16
    v_add_u32 v6, s28, v5
    v_add_u32 v7, s28, v6
    v_add_u32 v8, s28, v7
    s_movk_i32 s28, 576
    v_mul_lo_u32 v10, v15, s28
    v_lshl_add_u32 v10, v14, 4, v10
    v_add_u32 v10, 36864, v10
    v_lshrrev_b32 v14, 6, v0
    s_nop 1
    v_readfirstlane_b32 s29, v14
    s_and_b32 s30, s29, 1
    s_lshr_b32 s31, s29, 1
    v_and_b32 v14, 63, v0
    v_and_b32 v15, 31, v0
    v_bfe_u32 v16, v0, 5, 1
    s_mul_i32 s32, s31, 64
    v_add_u32 v11, s32, v15
    s_movk_i32 s28, 144
    v_mul_lo_u32 v11, v11, s28
    v_lshl_add_u32 v11, v16, 4, v11
    s_add_u32 s32, s32, s22
    v_add_u32 v13, s32, v15
    v_mul_lo_u32 v13, v13, s25
    v_lshl_add_u32 v13, v16, 3, v13
    s_mul_i32 s33, s30, 128
    s_add_u32 s33, s33, s21
    s_lshl_b32 s34, s33, 1
    v_add_u32 v13, s34, v13
    v_bfe_u32 v15, v0, 2, 2
    v_lshl_add_u32 v15, v16, 3, v15
    s_movk_i32 s28, 576
    v_mul_lo_u32 v12, v15, s28
    v_bfe_u32 v15, v0, 4, 1
    v_lshl_add_u32 v12, v15, 5, v12
    v_and_b32 v15, 3, v0
    v_lshl_add_u32 v12, v15, 3, v12
    s_mul_i32 s34, s30, 256
    s_add_u32 s34, s34, 36864
    v_add_u32 v12, s34, v12
    v_mov_b32 v112, 0
    v_mov_b32 v113, 0
    v_mov_b32 v114, 0
    v_mov_b32 v115, 0
    v_mov_b32 v116, 0
    v_mov_b32 v117, 0
    v_mov_b32 v118, 0
    v_mov_b32 v119, 0
    v_mov_b32 v120, 0
    v_mov_b32 v121, 0
    v_mov_b32 v122, 0
    v_mov_b32 v123, 0
    v_mov_b32 v124, 0
    v_mov_b32 v125, 0
    v_mov_b32 v126, 0
    v_mov_b32 v127, 0
    v_mov_b32 v128, 0
    v_mov_b32 v129, 0
    v_mov_b32 v130, 0
    v_mov_b32 v131, 0
    v_mov_b32 v132, 0
    v_mov_b32 v133, 0
    v_mov_b32 v134, 0
    v_mov_b32 v135, 0
    v_mov_b32 v136, 0
    v_mov_b32 v137, 0
    v_mov_b32 v138, 0
    v_mov_b32 v139, 0
    v_mov_b32 v140, 0
    v_mov_b32 v141, 0
    v_mov_b32 v142, 0
    v_mov_b32 v143, 0
    v_mov_b32 v144, 0
    v_mov_b32 v145, 0
    v_mov_b32 v146, 0
    v_mov_b32 v147, 0
    v_mov_b32 v148, 0
    v_mov_b32 v149, 0
    v_mov_b32 v150, 0
    v_mov_b32 v151, 0
    v_mov_b32 v152, 0
    v_mov_b32 v153, 0
    v_mov_b32 v154, 0
    v_mov_b32 v155, 0
    v_mov_b32 v156, 0
    v_mov_b32 v157, 0
    v_mov_b32 v158, 0
    v_mov_b32 v159, 0
    v_mov_b32 v160, 0
    v_mov_b32 v161, 0
    v_mov_b32 v162, 0
    v_mov_b32 v163, 0
    v_mov_b32 v164, 0
    v_mov_b32 v165, 0
    v_mov_b32 v166, 0
    v_mov_b32 v167, 0
    v_mov_b32 v168, 0
    v_mov_b32 v169, 0
    v_mov_b32 v170, 0
    v_mov_b32 v171, 0
    v_mov_b32 v172, 0
    v_mov_b32 v173, 0
    v_mov_b32 v174, 0
    v_mov_b32 v175, 0
    v_mov_b32 v176, 0
    v_mov_b32 v177, 0
    v_mov_b32 v178, 0
    v_mov_b32 v179, 0
    v_mov_b32 v180, 0
    v_mov_b32 v181, 0
    v_mov_b32 v182, 0
    v_mov_b32 v183, 0
    v_mov_b32 v184, 0
    v_mov_b32 v185, 0
    v_mov_b32 v186, 0
    v_mov_b32 v187, 0
    v_mov_b32 v188, 0
    v_mov_b32 v189, 0
    v_mov_b32 v190, 0
    v_mov_b32 v191, 0
    v_mov_b32 v192, 0
    v_mov_b32 v193, 0
    v_mov_b32 v194, 0
    v_mov_b32 v195, 0
    v_mov_b32 v196, 0
    v_mov_b32 v197, 0
    v_mov_b32 v198, 0
    v_mov_b32 v199, 0
    v_mov_b32 v200, 0
    v_mov_b32 v201, 0
    v_mov_b32 v202, 0
    v_mov_b32 v203, 0
    v_mov_b32 v204, 0
    v_mov_b32 v205, 0
    v_mov_b32 v206, 0
    v_mov_b32 v207, 0
    v_mov_b32 v208, 0
    v_mov_b32 v209, 0
    v_mov_b32 v210, 0
    v_mov_b32 v211, 0
    v_mov_b32 v212, 0
    v_mov_b32 v213, 0
    v_mov_b32 v214, 0
    v_mov_b32 v215, 0
    v_mov_b32 v216, 0
    v_mov_b32 v217, 0
    v_mov_b32 v218, 0
    v_mov_b32 v219, 0
    v_mov_b32 v220, 0
    v_mov_b32 v221, 0
    v_mov_b32 v222, 0
    v_mov_b32 v223, 0
    v_mov_b32 v224, 0
    v_mov_b32 v225, 0
    v_mov_b32 v226, 0
    v_mov_b32 v227, 0
    v_mov_b32 v228, 0
    v_mov_b32 v229, 0
    v_mov_b32 v230, 0
    v_mov_b32 v231, 0
    v_mov_b32 v232, 0
    v_mov_b32 v233, 0
    v_mov_b32 v234, 0
    v_mov_b32 v235, 0
    v_mov_b32 v236, 0
    v_mov_b32 v237, 0
    v_mov_b32 v238, 0
    v_mov_b32 v239, 0
    s_mov_b32 s35, 0
    s_mov_b32 s36, 0
    s_lshl_b32 s37, s24, 6
    s_mov_b32 s38, 73728
    buffer_load_dwordx4 v[68:71], v1, s[8:11], s35 offen
    buffer_load_dwordx4 v[72:75], v2, s[8:11], s35 offen
    buffer_load_dwordx4 v[76:79], v3, s[8:11], s35 offen
    buffer_load_dwordx4 v[80:83], v4, s[8:11], s35 offen
    buffer_load_dwordx4 v[84:87], v5, s[12:15], s36 offen
    buffer_load_dwordx4 v[88:91], v6, s[12:15], s36 offen
    buffer_load_dwordx4 v[92:95], v7, s[12:15], s36 offen
    buffer_load_dwordx4 v[96:99], v8, s[12:15], s36 offen
    s_add_u32 s35, s35, 128
    s_add_u32 s36, s36, s37
    s_waitcnt vmcnt(0)
    ds_write_b128 v9, v[68:71] offset:0
    ds_write_b128 v9, v[72:75] offset:9216
    ds_write_b128 v9, v[76:79] offset:18432
    ds_write_b128 v9, v[80:83] offset:27648
    ds_write_b128 v10, v[84:87] offset:0
    ds_write_b128 v10, v[88:91] offset:9216
    ds_write_b128 v10, v[92:95] offset:18432
    ds_write_b128 v10, v[96:99] offset:27648
    v_add_u32 v9, s38, v9
    v_add_u32 v10, s38, v10
    s_waitcnt lgkmcnt(0)
    s_barrier
kloop_1009:
    s_cmp_le_u32 s26, 1
    s_cbranch_scc1 nold_1010
    buffer_load_dwordx4 v[68:71], v1, s[8:11], s35 offen
    buffer_load_dwordx4 v[72:75], v2, s[8:11], s35 offen
    buffer_load_dwordx4 v[76:79], v3, s[8:11], s35 offen
    buffer_load_dwordx4 v[80:83], v4, s[8:11], s35 offen
    buffer_load_dwordx4 v[84:87], v5, s[12:15], s36 offen
    buffer_load_dwordx4 v[88:91], v6, s[12:15], s36 offen
    buffer_load_dwordx4 v[92:95], v7, s[12:15], s36 offen
    buffer_load_dwordx4 v[96:99], v8, s[12:15], s36 offen
    s_add_u32 s35, s35, 128
    s_add_u32 s36, s36, s37
nold_1010:
    ds_read_b128 v[20:23], v11 offset:0
    ds_read_b128 v[24:27], v11 offset:4608
    ds_read_b64_tr_b16 v[36:37], v12 offset:0
    ds_read_b64_tr_b16 v[38:39], v12 offset:2304
    ds_read_b64_tr_b16 v[40:41], v12 offset:64
    ds_read_b64_tr_b16 v[42:43], v12 offset:2368
    ds_read_b64_tr_b16 v[44:45], v12 offset:128
    ds_read_b64_tr_b16 v[46:47], v12 offset:2432
    ds_read_b64_tr_b16 v[48:49], v12 offset:192
    ds_read_b64_tr_b16 v[50:51], v12 offset:2496
    ds_read_b128 v[28:31], v11 offset:32
    ds_read_b128 v[32:35], v11 offset:4640
    ds_read_b64_tr_b16 v[52:53], v12 offset:9216
    ds_read_b64_tr_b16 v[54:55], v12 offset:11520
    ds_read_b64_tr_b16 v[56:57], v12 offset:9280
    ds_read_b64_tr_b16 v[58:59], v12 offset:11584
    ds_read_b64_tr_b16 v[60:61], v12 offset:9344
    ds_read_b64_tr_b16 v[62:63], v12 offset:11648
    ds_read_b64_tr_b16 v[64:65], v12 offset:9408
    ds_read_b64_tr_b16 v[66:67], v12 offset:11712
    s_waitcnt lgkmcnt(10)
    v_mfma_f32_32x32x16_bf16 v[112:127], v[36:39], v[20:23], v[112:127]
    v_mfma_f32_32x32x16_bf16 v[128:143], v[36:39], v[24:27], v[128:143]
    v_mfma_f32_32x32x16_bf16 v[144:159], v[40:43], v[20:23], v[144:159]
    v_mfma_f32_32x32x16_bf16 v[160:175], v[40:43], v[24:27], v[160:175]
    v_mfma_f32_32x32x16_bf16 v[176:191], v[44:47], v[20:23], v[176:191]
    v_mfma_f32_32x32x16_bf16 v[192:207], v[44:47], v[24:27], v[192:207]
    v_mfma_f32_32x32x16_bf16 v[208:223], v[48:51], v[20:23], v[208:223]
    v_mfma_f32_32x32x16_bf16 v[224:239], v[48:51], v[24:27], v[224:239]
    ds_read_b128 v[20:23], v11 offset:64
    ds_read_b128 v[24:27], v11 offset:4672
    ds_read_b64_tr_b16 v[36:37], v12 offset:18432
    ds_read_b64_tr_b16 v[38:39], v12 offset:20736
    ds_read_b64_tr_b16 v[40:41], v12 offset:18496
    ds_read_b64_tr_b16 v[42:43], v12 offset:20800
    ds_read_b64_tr_b16 v[44:45], v12 offset:18560
    ds_read_b64_tr_b16 v[46:47], v12 offset:20864
    ds_read_b64_tr_b16 v[48:49], v12 offset:18624
    ds_read_b64_tr_b16 v[50:51], v12 offset:20928
    s_waitcnt lgkmcnt(10)
    v_mfma_f32_32x32x16_bf16 v[112:127], v[52:55], v[28:31], v[112:127]
    v_mfma_f32_32x32x16_bf16 v[128:143], v[52:55], v[32:35], v[128:143]
    v_mfma_f32_32x32x16_bf16 v[144:159], v[56:59], v[28:31], v[144:159]
    v_mfma_f32_32x32x16_bf16 v[160:175], v[56:59], v[32:35], v[160:175]
    v_mfma_f32_32x32x16_bf16 v[176:191], v[60:63], v[28:31], v[176:191]
    v_mfma_f32_32x32x16_bf16 v[192:207], v[60:63], v[32:35], v[192:207]
    v_mfma_f32_32x32x16_bf16 v[208:223], v[64:67], v[28:31], v[208:223]
    v_mfma_f32_32x32x16_bf16 v[224:239], v[64:67], v[32:35], v[224:239]
    ds_read_b128 v[28:31], v11 offset:96
    ds_read_b128 v[32:35], v11 offset:4704
    ds_read_b64_tr_b16 v[52:53], v12 offset:27648
    ds_read_b64_tr_b16 v[54:55], v12 offset:29952
    ds_read_b64_tr_b16 v[56:57], v12 offset:27712
    ds_read_b64_tr_b16 v[58:59], v12 offset:30016
    ds_read_b64_tr_b16 v[60:61], v12 offset:27776
    ds_read_b64_tr_b16 v[62:63], v12 offset:30080
    ds_read_b64_tr_b16 v[64:65], v12 offset:27840
    ds_read_b64_tr_b16 v[66:67], v12 offset:30144
    s_waitcnt lgkmcnt(10)
    v_mfma_f32_32x32x16_bf16 v[112:127], v[36:39], v[20:23], v[112:127]
    v_mfma_f32_32x32x16_bf16 v[128:143], v[36:39], v[24:27], v[128:143]
    v_mfma_f32_32x32x16_bf16 v[144:159], v[40:43], v[20:23], v[144:159]
    v_mfma_f32_32x32x16_bf16 v[160:175], v[40:43], v[24:27], v[160:175]
    v_mfma_f32_32x32x16_bf16 v[176:191], v[44:47], v[20:23], v[176:191]
    v_mfma_f32_32x32x16_bf16 v[192:207], v[44:47], v[24:27], v[192:207]
    v_mfma_f32_32x32x16_bf16 v[208:223], v[48:51], v[20:23], v[208:223]
    v_mfma_f32_32x32x16_bf16 v[224:239], v[48:51], v[24:27], v[224:239]
    s_cmp_le_u32 s26, 1
    s_cbranch_scc1 nowr_1011
    s_waitcnt vmcnt(0)
    ds_write_b128 v9, v[68:71] offset:0
    ds_write_b128 v9, v[72:75] offset:9216
    ds_write_b128 v9, v[76:79] offset:18432
    ds_write_b128 v9, v[80:83] offset:27648
    ds_write_b128 v10, v[84:87] offset:0
    ds_write_b128 v10, v[88:91] offset:9216
    ds_write_b128 v10, v[92:95] offset:18432
    ds_write_b128 v10, v[96:99] offset:27648
nowr_1011:
    s_waitcnt lgkmcnt(0)
    v_mfma_f32_32x32x16_bf16 v[112:127], v[52:55], v[28:31], v[112:127]
    v_mfma_f32_32x32x16_bf16 v[128:143], v[52:55], v[32:35], v[128:143]
    v_mfma_f32_32x32x16_bf16 v[144:159], v[56:59], v[28:31], v[144:159]
    v_mfma_f32_32x32x16_bf16 v[160:175], v[56:59], v[32:35], v[160:175]
    v_mfma_f32_32x32x16_bf16 v[176:191], v[60:63], v[28:31], v[176:191]
    v_mfma_f32_32x32x16_bf16 v[192:207], v[60:63], v[32:35], v[192:207]
    v_mfma_f32_32x32x16_bf16 v[208:223], v[64:67], v[28:31], v[208:223]
    v_mfma_f32_32x32x16_bf16 v[224:239], v[64:67], v[32:35], v[224:239]
    v_add_u32 v11, s38, v11
    v_add_u32 v12, s38, v12
    s_sub_u32 s38, 0, s38
    v_add_u32 v9, s38, v9
    v_add_u32 v10, s38, v10
    s_waitcnt lgkmcnt(0)
    s_barrier
    s_sub_u32 s26, s26, 1
    s_cmp_gt_u32 s26, 0
    s_cbranch_scc1 kloop_1009
    s_nop 15
    s_nop 15
    s_mul_i32 s34, s29, 17408
    v_and_b32 v14, 31, v0
    s_movk_i32 s28, 272
    v_mul_lo_u32 v14, v14, s28
    v_bfe_u32 v15, v0, 5, 1
    v_lshl_add_u32 v14, v15, 3, v14
    v_add_u32 v14, s34, v14
    v_cvt_pk_bf16_f32 v112, v112, v113
    v_cvt_pk_bf16_f32 v113, v114, v115
    ds_write_b64 v14, v[112:113] offset:0
    v_cvt_pk_bf16_f32 v116, v116, v117
    v_cvt_pk_bf16_f32 v117, v118, v119
    ds_write_b64 v14, v[116:117] offset:16
    v_cvt_pk_bf16_f32 v120, v120, v121
    v_cvt_pk_bf16_f32 v121, v122, v123
    ds_write_b64 v14, v[120:121] offset:32
    v_cvt_pk_bf16_f32 v124, v124, v125
    v_cvt_pk_bf16_f32 v125, v126, v127
    ds_write_b64 v14, v[124:125] offset:48
    v_cvt_pk_bf16_f32 v128, v128, v129
    v_cvt_pk_bf16_f32 v129, v130, v131
    ds_write_b64 v14, v[128:129] offset:8704
    v_cvt_pk_bf16_f32 v132, v132, v133
    v_cvt_pk_bf16_f32 v133, v134, v135
    ds_write_b64 v14, v[132:133] offset:8720
    v_cvt_pk_bf16_f32 v136, v136, v137
    v_cvt_pk_bf16_f32 v137, v138, v139
    ds_write_b64 v14, v[136:137] offset:8736
    v_cvt_pk_bf16_f32 v140, v140, v141
    v_cvt_pk_bf16_f32 v141, v142, v143
    ds_write_b64 v14, v[140:141] offset:8752
    v_cvt_pk_bf16_f32 v144, v144, v145
    v_cvt_pk_bf16_f32 v145, v146, v147
    ds_write_b64 v14, v[144:145] offset:64
    v_cvt_pk_bf16_f32 v148, v148, v149
    v_cvt_pk_bf16_f32 v149, v150, v151
    ds_write_b64 v14, v[148:149] offset:80
    v_cvt_pk_bf16_f32 v152, v152, v153
    v_cvt_pk_bf16_f32 v153, v154, v155
    ds_write_b64 v14, v[152:153] offset:96
    v_cvt_pk_bf16_f32 v156, v156, v157
    v_cvt_pk_bf16_f32 v157, v158, v159
    ds_write_b64 v14, v[156:157] offset:112
    v_cvt_pk_bf16_f32 v160, v160, v161
    v_cvt_pk_bf16_f32 v161, v162, v163
    ds_write_b64 v14, v[160:161] offset:8768
    v_cvt_pk_bf16_f32 v164, v164, v165
    v_cvt_pk_bf16_f32 v165, v166, v167
    ds_write_b64 v14, v[164:165] offset:8784
    v_cvt_pk_bf16_f32 v168, v168, v169
    v_cvt_pk_bf16_f32 v169, v170, v171
    ds_write_b64 v14, v[168:169] offset:8800
    v_cvt_pk_bf16_f32 v172, v172, v173
    v_cvt_pk_bf16_f32 v173, v174, v175
    ds_write_b64 v14, v[172:173] offset:8816
    v_cvt_pk_bf16_f32 v176, v176, v177
    v_cvt_pk_bf16_f32 v177, v178, v179
    ds_write_b64 v14, v[176:177] offset:128
    v_cvt_pk_bf16_f32 v180, v180, v181
    v_cvt_pk_bf16_f32 v181, v182, v183
    ds_write_b64 v14, v[180:181] offset:144
    v_cvt_pk_bf16_f32 v184, v184, v185
    v_cvt_pk_bf16_f32 v185, v186, v187
    ds_write_b64 v14, v[184:185] offset:160
    v_cvt_pk_bf16_f32 v188, v188, v189
    v_cvt_pk_bf16_f32 v189, v190, v191
    ds_write_b64 v14, v[188:189] offset:176
    v_cvt_pk_bf16_f32 v192, v192, v193
    v_cvt_pk_bf16_f32 v193, v194, v195
    ds_write_b64 v14, v[192:193] offset:8832
    v_cvt_pk_bf16_f32 v196, v196, v197
    v_cvt_pk_bf16_f32 v197, v198, v199
    ds_write_b64 v14, v[196:197] offset:8848
    v_cvt_pk_bf16_f32 v200, v200, v201
    v_cvt_pk_bf16_f32 v201, v202, v203
    ds_write_b64 v14, v[200:201] offset:8864
    v_cvt_pk_bf16_f32 v204, v204, v205
    v_cvt_pk_bf16_f32 v205, v206, v207
    ds_write_b64 v14, v[204:205] offset:8880
    v_cvt_pk_bf16_f32 v208, v208, v209
    v_cvt_pk_bf16_f32 v209, v210, v211
    ds_write_b64 v14, v[208:209] offset:192
    v_cvt_pk_bf16_f32 v212, v212, v213
    v_cvt_pk_bf16_f32 v213, v214, v215
    ds_write_b64 v14, v[212:213] offset:208
    v_cvt_pk_bf16_f32 v216, v216, v217
    v_cvt_pk_bf16_f32 v217, v218, v219
    ds_write_b64 v14, v[216:217] offset:224
    v_cvt_pk_bf16_f32 v220, v220, v221
    v_cvt_pk_bf16_f32 v221, v222, v223
    ds_write_b64 v14, v[220:221] offset:240
    v_cvt_pk_bf16_f32 v224, v224, v225
    v_cvt_pk_bf16_f32 v225, v226, v227
    ds_write_b64 v14, v[224:225] offset:8896
    v_cvt_pk_bf16_f32 v228, v228, v229
    v_cvt_pk_bf16_f32 v229, v230, v231
    ds_write_b64 v14, v[228:229] offset:8912
    v_cvt_pk_bf16_f32 v232, v232, v233
    v_cvt_pk_bf16_f32 v233, v234, v235
    ds_write_b64 v14, v[232:233] offset:8928
    v_cvt_pk_bf16_f32 v236, v236, v237
    v_cvt_pk_bf16_f32 v237, v238, v239
    ds_write_b64 v14, v[236:237] offset:8944
    v_and_b32 v15, 63, v0
    v_lshrrev_b32 v16, 4, v15
    v_and_b32 v15, 15, v15
    v_mul_lo_u32 v14, v16, s28
    v_lshl_add_u32 v14, v15, 4, v14
    v_add_u32 v14, s34, v14
    v_add_u32 v16, s32, v16
    v_mul_lo_u32 v13, v16, s25
    v_lshl_add_u32 v13, v15, 4, v13
    s_lshl_b32 s39, s33, 1
    v_add_u32 v13, s39, v13
    v_lshl_add_u32 v15, v15, 3, s33
    v_cmp_gt_u32 vcc, s27, v15
    s_waitcnt lgkmcnt(0)
    ds_read_b128 v[112:115], v14 offset:0
    ds_read_b128 v[116:119], v14 offset:1088
    ds_read_b128 v[120:123], v14 offset:2176
    ds_read_b128 v[124:127], v14 offset:3264
    ds_read_b128 v[128:131], v14 offset:4352
    ds_read_b128 v[132:135], v14 offset:5440
    ds_read_b128 v[136:139], v14 offset:6528
    ds_read_b128 v[140:143], v14 offset:7616
    ds_read_b128 v[144:147], v14 offset:8704
    ds_read_b128 v[148:151], v14 offset:9792
    ds_read_b128 v[152:155], v14 offset:10880
    ds_read_b128 v[156:159], v14 offset:11968
    ds_read_b128 v[160:163], v14 offset:13056
    ds_read_b128 v[164:167], v14 offset:14144
    ds_read_b128 v[168:171], v14 offset:15232
    ds_read_b128 v[172:175], v14 offset:16320
    s_and_saveexec_b64 s[40:41], vcc
    s_mul_i32 s34, s25, 4
    s_mov_b32 s39, 0
    s_waitcnt lgkmcnt(15)
    buffer_store_dwordx4 v[112:115], v13, s[16:19], s39 offen
    s_add_u32 s39, s39, s34
    s_waitcnt lgkmcnt(14)
    buffer_store_dwordx4 v[116:119], v13, s[16:19], s39 offen
    s_add_u32 s39, s39, s34
    s_waitcnt lgkmcnt(13)
    buffer_store_dwordx4 v[120:123], v13, s[16:19], s39 offen
    s_add_u32 s39, s39, s34
    s_waitcnt lgkmcnt(12)
    buffer_store_dwordx4 v[124:127], v13, s[16:19], s39 offen
    s_add_u32 s39, s39, s34
    s_waitcnt lgkmcnt(11)
    buffer_store_dwordx4 v[128:131], v13, s[16:19], s39 offen
    s_add_u32 s39, s39, s34
    s_waitcnt lgkmcnt(10)
    buffer_store_dwordx4 v[132:135], v13, s[16:19], s39 offen
    s_add_u32 s39, s39, s34
    s_waitcnt lgkmcnt(9)
    buffer_store_dwordx4 v[136:139], v13, s[16:19], s39 offen
    s_add_u32 s39, s39, s34
    s_waitcnt lgkmcnt(8)
    buffer_store_dwordx4 v[140:143], v13, s[16:19], s39 offen
    s_add_u32 s39, s39, s34
    s_waitcnt lgkmcnt(7)
    buffer_store_dwordx4 v[144:147], v13, s[16:19], s39 offen
    s_add_u32 s39, s39, s34
    s_waitcnt lgkmcnt(6)
    buffer_store_dwordx4 v[148:151], v13, s[16:19], s39 offen
    s_add_u32 s39, s39, s34
    s_waitcnt lgkmcnt(5)
    buffer_store_dwordx4 v[152:155], v13, s[16:19], s39 offen
    s_add_u32 s39, s39, s34
    s_waitcnt lgkmcnt(4)
    buffer_store_dwordx4 v[156:159], v13, s[16:19], s39 offen
    s_add_u32 s39, s39, s34
    s_waitcnt lgkmcnt(3)
    buffer_store_dwordx4 v[160:163], v13, s[16:19], s39 offen
    s_add_u32 s39, s39, s34
    s_waitcnt lgkmcnt(2)
    buffer_store_dwordx4 v[164:167], v13, s[16:19], s39 offen
    s_add_u32 s39, s39, s34
    s_waitcnt lgkmcnt(1)
    buffer_store_dwordx4 v[168:171], v13, s[16:19], s39 offen
    s_add_u32 s39, s39, s34
    s_waitcnt lgkmcnt(0)
    buffer_store_dwordx4 v[172:175], v13, s[16:19], s39 offen
    s_add_u32 s39, s39, s34
    s_mov_b64 exec, s[40:41]
done_1002:
    s_endpgm
.globl attnb_kernel
.p2align 8
.type attnb_kernel,@function
attnb_kernel:
    s_cmp_ge_u32 s2, 512
    s_cbranch_scc1 attna_part
    s_load_dwordx2 s[4:5], s[0:1], 104
    s_cmp_ge_u32 s2, 512
    s_cbranch_scc1 done_2001
    s_and_b32 s20, s2, 31
    s_lshr_b32 s21, s2, 5
    s_sub_u32 s19, 15, s21
    s_sub_u32 s21, s21, 8
    s_cmp_lt_u32 s2, 256
    s_cselect_b32 s21, s19, s21
    s_waitcnt lgkmcnt(0)
    s_add_u32 s8, s4, 0
    s_addc_u32 s9, s5, 0
    s_mov_b32 s10, 16777216
    s_mov_b32 s11, 0x00020000
    s_add_u32 s12, s4, 16777216
    s_addc_u32 s13, s5, 0
    s_mov_b32 s14, 16777216
    s_mov_b32 s15, 0x00020000
    s_add_u32 s16, s4, 33554432
    s_addc_u32 s17, s5, 0
    s_mov_b32 s18, 16777216
    s_mov_b32 s19, 0x00020000
    s_add_u32 s24, s4, 58720256
    s_addc_u32 s25, s5, 0
    s_mov_b32 s26, 16777216
    s_mov_b32 s27, 0x00020000
    s_lshl_b32 s22, s20, 8
    v_lshrrev_b32 v11, 6, v0
    s_nop 1
    v_readfirstlane_b32 s23, v11
    v_and_b32 v11, 15, v0
    v_lshrrev_b32 v12, 4, v0
    v_lshlrev_b32 v1, 13, v12
    v_lshl_add_u32 v1, v11, 4, v1
    v_add_u32 v1, s22, v1
    s_movk_i32 s28, 272
    v_mul_lo_u32 v3, v12, s28
    v_lshl_add_u32 v3, v11, 4, v3
    s_movk_i32 s28, 320
    v_mul_lo_u32 v4, v12, s28
    v_lshl_add_u32 v4, v11, 4, v4
    v_add_u32 v4, 17408, v4
    v_and_b32 v11, 31, v0
    v_bfe_u32 v12, v0, 5, 1
    s_movk_i32 s28, 272
    v_mul_lo_u32 v5, v11, s28
    v_lshl_add_u32 v5, v12, 4, v5
    v_bfe_u32 v13, v0, 2, 2
    v_lshl_add_u32 v13, v12, 2, v13
    s_movk_i32 s28, 320
    v_mul_lo_u32 v6, v13, s28
    v_bfe_u32 v13, v0, 4, 1
    v_lshl_add_u32 v6, v13, 5, v6
    v_and_b32 v13, 3, v0
    v_lshl_add_u32 v6, v13, 3, v6
    v_add_u32 v6, 17408, v6
    s_lshl_b32 s29, s21, 7
    s_lshl_b32 s30, s23, 5
    s_add_u32 s29, s29, s30
    v_add_u32 v7, s29, v11
    v_lshlrev_b32 v13, 13, v7
    v_lshl_add_u32 v13, v12, 4, v13
    v_add_u32 v13, s22, v13
    buffer_load_dwordx4 v[16:19], v13, s[8:11], 0 offen offset:0
    buffer_load_dwordx4 v[20:23], v13, s[8:11], 0 offen offset:32
    buffer_load_dwordx4 v[24:27], v13, s[8:11], 0 offen offset:64
    buffer_load_dwordx4 v[28:31], v13, s[8:11], 0 offen offset:96
    buffer_load_dwordx4 v[32:35], v13, s[8:11], 0 offen offset:128
    buffer_load_dwordx4 v[36:39], v13, s[8:11], 0 offen offset:160
    buffer_load_dwordx4 v[40:43], v13, s[8:11], 0 offen offset:192
    buffer_load_dwordx4 v[44:47], v13, s[8:11], 0 offen offset:224
    v_lshlrev_b32 v14, 2, v12
    v_sub_u32 v14, v7, v14
    v_mov_b32 v8, 0xf149f2ca
    v_mov_b32 v9, 0
    v_mov_b32 v15, 0xf149f2ca
    v_mov_b32 v160, 0
    v_mov_b32 v161, 0
    v_mov_b32 v162, 0
    v_mov_b32 v163, 0
    v_mov_b32 v164, 0
    v_mov_b32 v165, 0
    v_mov_b32 v166, 0
    v_mov_b32 v167, 0
    v_mov_b32 v168, 0
    v_mov_b32 v169, 0
    v_mov_b32 v170, 0
    v_mov_b32 v171, 0
    v_mov_b32 v172, 0
    v_mov_b32 v173, 0
    v_mov_b32 v174, 0
    v_mov_b32 v175, 0
    v_mov_b32 v176, 0
    v_mov_b32 v177, 0
    v_mov_b32 v178, 0
    v_mov_b32 v179, 0
    v_mov_b32 v180, 0
    v_mov_b32 v181, 0
    v_mov_b32 v182, 0
    v_mov_b32 v183, 0
    v_mov_b32 v184, 0
    v_mov_b32 v185, 0
    v_mov_b32 v186, 0
    v_mov_b32 v187, 0
    v_mov_b32 v188, 0
    v_mov_b32 v189, 0
    v_mov_b32 v190, 0
    v_mov_b32 v191, 0
    v_mov_b32 v192, 0
    v_mov_b32 v193, 0
    v_mov_b32 v194, 0
    v_mov_b32 v195, 0
    v_mov_b32 v196, 0
    v_mov_b32 v197, 0
    v_mov_b32 v198, 0
    v_mov_b32 v199, 0
    v_mov_b32 v200, 0
    v_mov_b32 v201, 0
    v_mov_b32 v202, 0
    v_mov_b32 v203, 0
    v_mov_b32 v204, 0
    v_mov_b32 v205, 0
    v_mov_b32 v206, 0
    v_mov_b32 v207, 0
    v_mov_b32 v208, 0
    v_mov_b32 v209, 0
    v_mov_b32 v210, 0
    v_mov_b32 v211, 0
    v_mov_b32 v212, 0
    v_mov_b32 v213, 0
    v_mov_b32 v214, 0
    v_mov_b32 v215, 0
    v_mov_b32 v216, 0
    v_mov_b32 v217, 0
    v_mov_b32 v218, 0
    v_mov_b32 v219, 0
    v_mov_b32 v220, 0
    v_mov_b32 v221, 0
    v_mov_b32 v222, 0
    v_mov_b32 v223, 0
    s_mov_b32 s31, 1040356334
    s_lshl_b32 s32, s21, 1
    s_add_u32 s32, s32, 2
    s_mov_b32 s33, 0
    s_mov_b32 s35, 0
    s_mov_b32 s38, 37888
    s_add_u32 s36, s35, 0
    buffer_load_dwordx4 v[48:51], v1, s[12:15], s36 offen
    buffer_load_dwordx4 v[64:67], v1, s[16:19], s36 offen
    s_add_u32 s36, s35, 131072
    buffer_load_dwordx4 v[52:55], v1, s[12:15], s36 offen
    buffer_load_dwordx4 v[68:71], v1, s[16:19], s36 offen
    s_add_u32 s36, s35, 262144
    buffer_load_dwordx4 v[56:59], v1, s[12:15], s36 offen
    buffer_load_dwordx4 v[72:75], v1, s[16:19], s36 offen
    s_add_u32 s36, s35, 393216
    buffer_load_dwordx4 v[60:63], v1, s[12:15], s36 offen
    buffer_load_dwordx4 v[76:79], v1, s[16:19], s36 offen
    s_add_u32 s35, s35, 524288
    s_waitcnt vmcnt(0)
    ds_write_b128 v3, v[48:51] offset:0
    ds_write_b128 v4, v[64:67] offset:0
    ds_write_b128 v3, v[52:55] offset:4352
    ds_write_b128 v4, v[68:71] offset:5120
    ds_write_b128 v3, v[56:59] offset:8704
    ds_write_b128 v4, v[72:75] offset:10240
    ds_write_b128 v3, v[60:63] offset:13056
    ds_write_b128 v4, v[76:79] offset:15360
    v_add_u32 v3, s38, v3
    v_add_u32 v4, s38, v4
    s_waitcnt lgkmcnt(0)
    s_barrier
loop_2002:
    s_add_u32 s34, s33, 1
    s_cmp_ge_u32 s34, s32
    s_cbranch_scc1 nold_2003
    s_add_u32 s36, s35, 0
    buffer_load_dwordx4 v[48:51], v1, s[12:15], s36 offen
    buffer_load_dwordx4 v[64:67], v1, s[16:19], s36 offen
    s_add_u32 s36, s35, 131072
    buffer_load_dwordx4 v[52:55], v1, s[12:15], s36 offen
    buffer_load_dwordx4 v[68:71], v1, s[16:19], s36 offen
    s_add_u32 s36, s35, 262144
    buffer_load_dwordx4 v[56:59], v1, s[12:15], s36 offen
    buffer_load_dwordx4 v[72:75], v1, s[16:19], s36 offen
    s_add_u32 s36, s35, 393216
    buffer_load_dwordx4 v[60:63], v1, s[12:15], s36 offen
    buffer_load_dwordx4 v[76:79], v1, s[16:19], s36 offen
    s_add_u32 s35, s35, 524288
nold_2003:
    ds_read_b128 v[128:131], v5 offset:0
    ds_read_b128 v[132:135], v5 offset:32
    ds_read_b128 v[136:139], v5 offset:64
    ds_read_b128 v[140:143], v5 offset:96
    ds_read_b128 v[144:147], v5 offset:128
    ds_read_b128 v[148:151], v5 offset:160
    ds_read_b128 v[152:155], v5 offset:192
    ds_read_b128 v[156:159], v5 offset:224
    s_waitcnt lgkmcnt(7)
    v_mfma_f32_32x32x16_bf16 v[80:95], v[128:131], v[16:19], 0
    s_waitcnt lgkmcnt(6)
    v_mfma_f32_32x32x16_bf16 v[80:95], v[132:135], v[20:23], v[80:95]
    s_waitcnt lgkmcnt(5)
    v_mfma_f32_32x32x16_bf16 v[80:95], v[136:139], v[24:27], v[80:95]
    s_waitcnt lgkmcnt(4)
    v_mfma_f32_32x32x16_bf16 v[80:95], v[140:143], v[28:31], v[80:95]
    s_waitcnt lgkmcnt(3)
    v_mfma_f32_32x32x16_bf16 v[80:95], v[144:147], v[32:35], v[80:95]
    s_waitcnt lgkmcnt(2)
    v_mfma_f32_32x32x16_bf16 v[80:95], v[148:151], v[36:39], v[80:95]
    s_waitcnt lgkmcnt(1)
    v_mfma_f32_32x32x16_bf16 v[80:95], v[152:155], v[40:43], v[80:95]
    s_waitcnt lgkmcnt(0)
    v_mfma_f32_32x32x16_bf16 v[80:95], v[156:159], v[44:47], v[80:95]
    ds_read_b128 v[128:131], v5 offset:8704
    ds_read_b128 v[132:135], v5 offset:8736
    ds_read_b128 v[136:139], v5 offset:8768
    ds_read_b128 v[140:143], v5 offset:8800
    ds_read_b128 v[144:147], v5 offset:8832
    ds_read_b128 v[148:151], v5 offset:8864
    ds_read_b128 v[152:155], v5 offset:8896
    ds_read_b128 v[156:159], v5 offset:8928
    s_waitcnt lgkmcnt(7)
    v_mfma_f32_32x32x16_bf16 v[96:111], v[128:131], v[16:19], 0
    s_waitcnt lgkmcnt(6)
    v_mfma_f32_32x32x16_bf16 v[96:111], v[132:135], v[20:23], v[96:111]
    s_waitcnt lgkmcnt(5)
    v_mfma_f32_32x32x16_bf16 v[96:111], v[136:139], v[24:27], v[96:111]
    s_waitcnt lgkmcnt(4)
    v_mfma_f32_32x32x16_bf16 v[96:111], v[140:143], v[28:31], v[96:111]
    s_waitcnt lgkmcnt(3)
    v_mfma_f32_32x32x16_bf16 v[96:111], v[144:147], v[32:35], v[96:111]
    s_waitcnt lgkmcnt(2)
    v_mfma_f32_32x32x16_bf16 v[96:111], v[148:151], v[36:39], v[96:111]
    s_waitcnt lgkmcnt(1)
    v_mfma_f32_32x32x16_bf16 v[96:111], v[152:155], v[40:43], v[96:111]
    s_waitcnt lgkmcnt(0)
    v_mfma_f32_32x32x16_bf16 v[96:111], v[156:159], v[44:47], v[96:111]
    s_nop 15
    s_add_u32 s34, s33, 2
    s_cmp_lt_u32 s34, s32
    s_cbranch_scc1 nomask_2005
    s_lshl_b32 s34, s33, 6
    s_add_u32 s36, s34, 0
    v_cmp_lt_i32 vcc, v14, s36
    s_nop 1
    v_cndmask_b32 v80, v80, v15, vcc
    s_add_u32 s36, s34, 1
    v_cmp_lt_i32 vcc, v14, s36
    s_nop 1
    v_cndmask_b32 v81, v81, v15, vcc
    s_add_u32 s36, s34, 2
    v_cmp_lt_i32 vcc, v14, s36
    s_nop 1
    v_cndmask_b32 v82, v82, v15, vcc
    s_add_u32 s36, s34, 3
    v_cmp_lt_i32 vcc, v14, s36
    s_nop 1
    v_cndmask_b32 v83, v83, v15, vcc
    s_add_u32 s36, s34, 8
    v_cmp_lt_i32 vcc, v14, s36
    s_nop 1
    v_cndmask_b32 v84, v84, v15, vcc
    s_add_u32 s36, s34, 9
    v_cmp_lt_i32 vcc, v14, s36
    s_nop 1
    v_cndmask_b32 v85, v85, v15, vcc
    s_add_u32 s36, s34, 10
    v_cmp_lt_i32 vcc, v14, s36
    s_nop 1
    v_cndmask_b32 v86, v86, v15, vcc
    s_add_u32 s36, s34, 11
    v_cmp_lt_i32 vcc, v14, s36
    s_nop 1
    v_cndmask_b32 v87, v87, v15, vcc
    s_add_u32 s36, s34, 16
    v_cmp_lt_i32 vcc, v14, s36
    s_nop 1
    v_cndmask_b32 v88, v88, v15, vcc
    s_add_u32 s36, s34, 17
    v_cmp_lt_i32 vcc, v14, s36
    s_nop 1
    v_cndmask_b32 v89, v89, v15, vcc
    s_add_u32 s36, s34, 18
    v_cmp_lt_i32 vcc, v14, s36
    s_nop 1
    v_cndmask_b32 v90, v90, v15, vcc
    s_add_u32 s36, s34, 19
    v_cmp_lt_i32 vcc, v14, s36
    s_nop 1
    v_cndmask_b32 v91, v91, v15, vcc
    s_add_u32 s36, s34, 24
    v_cmp_lt_i32 vcc, v14, s36
    s_nop 1
    v_cndmask_b32 v92, v92, v15, vcc
    s_add_u32 s36, s34, 25
    v_cmp_lt_i32 vcc, v14, s36
    s_nop 1
    v_cndmask_b32 v93, v93, v15, vcc
    s_add_u32 s36, s34, 26
    v_cmp_lt_i32 vcc, v14, s36
    s_nop 1
    v_cndmask_b32 v94, v94, v15, vcc
    s_add_u32 s36, s34, 27
    v_cmp_lt_i32 vcc, v14, s36
    s_nop 1
    v_cndmask_b32 v95, v95, v15, vcc
    s_add_u32 s36, s34, 32
    v_cmp_lt_i32 vcc, v14, s36
    s_nop 1
    v_cndmask_b32 v96, v96, v15, vcc
    s_add_u32 s36, s34, 33
    v_cmp_lt_i32 vcc, v14, s36
    s_nop 1
    v_cndmask_b32 v97, v97, v15, vcc
    s_add_u32 s36, s34, 34
    v_cmp_lt_i32 vcc, v14, s36
    s_nop 1
    v_cndmask_b32 v98, v98, v15, vcc
    s_add_u32 s36, s34, 35
    v_cmp_lt_i32 vcc, v14, s36
    s_nop 1
    v_cndmask_b32 v99, v99, v15, vcc
    s_add_u32 s36, s34, 40
    v_cmp_lt_i32 vcc, v14, s36
    s_nop 1
    v_cndmask_b32 v100, v100, v15, vcc
    s_add_u32 s36, s34, 41
    v_cmp_lt_i32 vcc, v14, s36
    s_nop 1
    v_cndmask_b32 v101, v101, v15, vcc
    s_add_u32 s36, s34, 42
    v_cmp_lt_i32 vcc, v14, s36
    s_nop 1
    v_cndmask_b32 v102, v102, v15, vcc
    s_add_u32 s36, s34, 43
    v_cmp_lt_i32 vcc, v14, s36
    s_nop 1
    v_cndmask_b32 v103, v103, v15, vcc
    s_add_u32 s36, s34, 48
    v_cmp_lt_i32 vcc, v14, s36
    s_nop 1
    v_cndmask_b32 v104, v104, v15, vcc
    s_add_u32 s36, s34, 49
    v_cmp_lt_i32 vcc, v14, s36
    s_nop 1
    v_cndmask_b32 v105, v105, v15, vcc
    s_add_u32 s36, s34, 50
    v_cmp_lt_i32 vcc, v14, s36
    s_nop 1
    v_cndmask_b32 v106, v106, v15, vcc
    s_add_u32 s36, s34, 51
    v_cmp_lt_i32 vcc, v14, s36
    s_nop 1
    v_cndmask_b32 v107, v107, v15, vcc
    s_add_u32 s36, s34, 56
    v_cmp_lt_i32 vcc, v14, s36
    s_nop 1
    v_cndmask_b32 v108, v108, v15, vcc
    s_add_u32 s36, s34, 57
    v_cmp_lt_i32 vcc, v14, s36
    s_nop 1
    v_cndmask_b32 v109, v109, v15, vcc
    s_add_u32 s36, s34, 58
    v_cmp_lt_i32 vcc, v14, s36
    s_nop 1
    v_cndmask_b32 v110, v110, v15, vcc
    s_add_u32 s36, s34, 59
    v_cmp_lt_i32 vcc, v14, s36
    s_nop 1
    v_cndmask_b32 v111, v111, v15, vcc
nomask_2005:
    v_max3_f32 v10, v80, v81, v82
    v_max3_f32 v10, v10, v83, v84
    v_max3_f32 v10, v10, v85, v86
    v_max3_f32 v10, v10, v87, v88
    v_max3_f32 v10, v10, v89, v90
    v_max3_f32 v10, v10, v91, v92
    v_max3_f32 v10, v10, v93, v94
    v_max3_f32 v10, v10, v95, v96
    v_max3_f32 v10, v10, v97, v98
    v_max3_f32 v10, v10, v99, v100
    v_max3_f32 v10, v10, v101, v102
    v_max3_f32 v10, v10, v103, v104
    v_max3_f32 v10, v10, v105, v106
    v_max3_f32 v10, v10, v107, v108
    v_max3_f32 v10, v10, v109, v110
    v_max_f32 v10, v10, v111
    v_mov_b32 v11, v10
    s_nop 1
    v_permlane32_swap_b32 v10, v11
    v_max_f32 v10, v10, v11
    v_max_f32 v10, v10, v8
    v_cmp_gt_f32 vcc, v10, v8
    v_sub_f32 v11, v8, v10
    v_mul_f32 v11, s31, v11
    v_exp_f32 v11, v11
    v_mov_b32 v8, v10
    v_mul_f32 v10, s31, v10
    v_fma_f32 v80, v80, s31, -v10
    v_fma_f32 v81, v81, s31, -v10
    v_fma_f32 v82, v82, s31, -v10
    v_fma_f32 v83, v83, s31, -v10
    v_fma_f32 v84, v84, s31, -v10
    v_fma_f32 v85, v85, s31, -v10
    v_fma_f32 v86, v86, s31, -v10
    v_fma_f32 v87, v87, s31, -v10
    v_fma_f32 v88, v88, s31, -v10
    v_fma_f32 v89, v89, s31, -v10
    v_fma_f32 v90, v90, s31, -v10
    v_fma_f32 v91, v91, s31, -v10
    v_fma_f32 v92, v92, s31, -v10
    v_fma_f32 v93, v93, s31, -v10
    v_fma_f32 v94, v94, s31, -v10
    v_fma_f32 v95, v95, s31, -v10
    v_fma_f32 v96, v96, s31, -v10
    v_fma_f32 v97, v97, s31, -v10
    v_fma_f32 v98, v98, s31, -v10
    v_fma_f32 v99, v99, s31, -v10
    v_fma_f32 v100, v100, s31, -v10
    v_fma_f32 v101, v101, s31, -v10
    v_fma_f32 v102, v102, s31, -v10
    v_fma_f32 v103, v103, s31, -v10
    v_fma_f32 v104, v104, s31, -v10
    v_fma_f32 v105, v105, s31, -v10
    v_fma_f32 v106, v106, s31, -v10
    v_fma_f32 v107, v107, s31, -v10
    v_fma_f32 v108, v108, s31, -v10
    v_fma_f32 v109, v109, s31, -v10
    v_fma_f32 v110, v110, s31, -v10
    v_fma_f32 v111, v111, s31, -v10
    v_exp_f32 v80, v80
    v_exp_f32 v81, v81
    v_exp_f32 v82, v82
    v_exp_f32 v83, v83
    v_exp_f32 v84, v84
    v_exp_f32 v85, v85
    v_exp_f32 v86, v86
    v_exp_f32 v87, v87
    v_exp_f32 v88, v88
    v_exp_f32 v89, v89
    v_exp_f32 v90, v90
    v_exp_f32 v91, v91
    v_exp_f32 v92, v92
    v_exp_f32 v93, v93
    v_exp_f32 v94, v94
    v_exp_f32 v95, v95
    v_exp_f32 v96, v96
    v_exp_f32 v97, v97
    v_exp_f32 v98, v98
    v_exp_f32 v99, v99
    v_exp_f32 v100, v100
    v_exp_f32 v101, v101
    v_exp_f32 v102, v102
    v_exp_f32 v103, v103
    v_exp_f32 v104, v104
    v_exp_f32 v105, v105
    v_exp_f32 v106, v106
    v_exp_f32 v107, v107
    v_exp_f32 v108, v108
    v_exp_f32 v109, v109
    v_exp_f32 v110, v110
    v_exp_f32 v111, v111
    s_cbranch_vccz norescale_2006
    v_mul_f32 v9, v9, v11
    v_mul_f32 v160, v160, v11
    v_mul_f32 v161, v161, v11
    v_mul_f32 v162, v162, v11
    v_mul_f32 v163, v163, v11
    v_mul_f32 v164, v164, v11
    v_mul_f32 v165, v165, v11
    v_mul_f32 v166, v166, v11
    v_mul_f32 v167, v167, v11
    v_mul_f32 v168, v168, v11
    v_mul_f32 v169, v169, v11
    v_mul_f32 v170, v170, v11
    v_mul_f32 v171, v171, v11
    v_mul_f32 v172, v172, v11
    v_mul_f32 v173, v173, v11
    v_mul_f32 v174, v174, v11
    v_mul_f32 v175, v175, v11
    v_mul_f32 v176, v176, v11
    v_mul_f32 v177, v177, v11
    v_mul_f32 v178, v178, v11
    v_mul_f32 v179, v179, v11
    v_mul_f32 v180, v180, v11
    v_mul_f32 v181, v181, v11
    v_mul_f32 v182, v182, v11
    v_mul_f32 v183, v183, v11
    v_mul_f32 v184, v184, v11
    v_mul_f32 v185, v185, v11
    v_mul_f32 v186, v186, v11
    v_mul_f32 v187, v187, v11
    v_mul_f32 v188, v188, v11
    v_mul_f32 v189, v189, v11
    v_mul_f32 v190, v190, v11
    v_mul_f32 v191, v191, v11
    v_mul_f32 v192, v192, v11
    v_mul_f32 v193, v193, v11
    v_mul_f32 v194, v194, v11
    v_mul_f32 v195, v195, v11
    v_mul_f32 v196, v196, v11
    v_mul_f32 v197, v197, v11
    v_mul_f32 v198, v198, v11
    v_mul_f32 v199, v199, v11
    v_mul_f32 v200, v200, v11
    v_mul_f32 v201, v201, v11
    v_mul_f32 v202, v202, v11
    v_mul_f32 v203, v203, v11
    v_mul_f32 v204, v204, v11
    v_mul_f32 v205, v205, v11
    v_mul_f32 v206, v206, v11
    v_mul_f32 v207, v207, v11
    v_mul_f32 v208, v208, v11
    v_mul_f32 v209, v209, v11
    v_mul_f32 v210, v210, v11
    v_mul_f32 v211, v211, v11
    v_mul_f32 v212, v212, v11
    v_mul_f32 v213, v213, v11
    v_mul_f32 v214, v214, v11
    v_mul_f32 v215, v215, v11
    v_mul_f32 v216, v216, v11
    v_mul_f32 v217, v217, v11
    v_mul_f32 v218, v218, v11
    v_mul_f32 v219, v219, v11
    v_mul_f32 v220, v220, v11
    v_mul_f32 v221, v221, v11
    v_mul_f32 v222, v222, v11
    v_mul_f32 v223, v223, v11
norescale_2006:
    v_add_f32 v9, v9, v80
    v_add_f32 v9, v9, v81
    v_add_f32 v9, v9, v82
    v_add_f32 v9, v9, v83
    v_add_f32 v9, v9, v84
    v_add_f32 v9, v9, v85
    v_add_f32 v9, v9, v86
    v_add_f32 v9, v9, v87
    v_add_f32 v9, v9, v88
    v_add_f32 v9, v9, v89
    v_add_f32 v9, v9, v90
    v_add_f32 v9, v9, v91
    v_add_f32 v9, v9, v92
    v_add_f32 v9, v9, v93
    v_add_f32 v9, v9, v94
    v_add_f32 v9, v9, v95
    v_add_f32 v9, v9, v96
    v_add_f32 v9, v9, v97
    v_add_f32 v9, v9, v98
    v_add_f32 v9, v9, v99
    v_add_f32 v9, v9, v100
    v_add_f32 v9, v9, v101
    v_add_f32 v9, v9, v102
    v_add_f32 v9, v9, v103
    v_add_f32 v9, v9, v104
    v_add_f32 v9, v9, v105
    v_add_f32 v9, v9, v106
    v_add_f32 v9, v9, v107
    v_add_f32 v9, v9, v108
    v_add_f32 v9, v9, v109
    v_add_f32 v9, v9, v110
    v_add_f32 v9, v9, v111
    v_cvt_pk_bf16_f32 v112, v80, v81
    v_cvt_pk_bf16_f32 v113, v82, v83
    v_cvt_pk_bf16_f32 v114, v84, v85
    v_cvt_pk_bf16_f32 v115, v86, v87
    v_cvt_pk_bf16_f32 v116, v88, v89
    v_cvt_pk_bf16_f32 v117, v90, v91
    v_cvt_pk_bf16_f32 v118, v92, v93
    v_cvt_pk_bf16_f32 v119, v94, v95
    v_cvt_pk_bf16_f32 v120, v96, v97
    v_cvt_pk_bf16_f32 v121, v98, v99
    v_cvt_pk_bf16_f32 v122, v100, v101
    v_cvt_pk_bf16_f32 v123, v102, v103
    v_cvt_pk_bf16_f32 v124, v104, v105
    v_cvt_pk_bf16_f32 v125, v106, v107
    v_cvt_pk_bf16_f32 v126, v108, v109
    v_cvt_pk_bf16_f32 v127, v110, v111
    ds_read_b64_tr_b16 v[128:129], v6 offset:0
    ds_read_b64_tr_b16 v[130:131], v6 offset:2560
    ds_read_b64_tr_b16 v[132:133], v6 offset:64
    ds_read_b64_tr_b16 v[134:135], v6 offset:2624
    ds_read_b64_tr_b16 v[136:137], v6 offset:128
    ds_read_b64_tr_b16 v[138:139], v6 offset:2688
    ds_read_b64_tr_b16 v[140:141], v6 offset:192
    ds_read_b64_tr_b16 v[142:143], v6 offset:2752
    ds_read_b64_tr_b16 v[144:145], v6 offset:5120
    ds_read_b64_tr_b16 v[146:147], v6 offset:7680
    ds_read_b64_tr_b16 v[148:149], v6 offset:5184
    ds_read_b64_tr_b16 v[150:151], v6 offset:7744
    ds_read_b64_tr_b16 v[152:153], v6 offset:5248
    ds_read_b64_tr_b16 v[154:155], v6 offset:7808
    ds_read_b64_tr_b16 v[156:157], v6 offset:5312
    ds_read_b64_tr_b16 v[158:159], v6 offset:7872
    s_waitcnt lgkmcnt(8)
    v_mfma_f32_32x32x16_bf16 v[160:175], v[128:131], v[112:115], v[160:175]
    v_mfma_f32_32x32x16_bf16 v[176:191], v[132:135], v[112:115], v[176:191]
    v_mfma_f32_32x32x16_bf16 v[192:207], v[136:139], v[112:115], v[192:207]
    v_mfma_f32_32x32x16_bf16 v[208:223], v[140:143], v[112:115], v[208:223]
    ds_read_b64_tr_b16 v[128:129], v6 offset:10240
    ds_read_b64_tr_b16 v[130:131], v6 offset:12800
    ds_read_b64_tr_b16 v[132:133], v6 offset:10304
    ds_read_b64_tr_b16 v[134:135], v6 offset:12864
    ds_read_b64_tr_b16 v[136:137], v6 offset:10368
    ds_read_b64_tr_b16 v[138:139], v6 offset:12928
    ds_read_b64_tr_b16 v[140:141], v6 offset:10432
    ds_read_b64_tr_b16 v[142:143], v6 offset:12992
    s_waitcnt lgkmcnt(8)
    v_mfma_f32_32x32x16_bf16 v[160:175], v[144:147], v[116:119], v[160:175]
    v_mfma_f32_32x32x16_bf16 v[176:191], v[148:151], v[116:119], v[176:191]
    v_mfma_f32_32x32x16_bf16 v[192:207], v[152:155], v[116:119], v[192:207]
    v_mfma_f32_32x32x16_bf16 v[208:223], v[156:159], v[116:119], v[208:223]
    ds_read_b64_tr_b16 v[144:145], v6 offset:15360
    ds_read_b64_tr_b16 v[146:147], v6 offset:17920
    ds_read_b64_tr_b16 v[148:149], v6 offset:15424
    ds_read_b64_tr_b16 v[150:151], v6 offset:17984
    ds_read_b64_tr_b16 v[152:153], v6 offset:15488
    ds_read_b64_tr_b16 v[154:155], v6 offset:18048
    ds_read_b64_tr_b16 v[156:157], v6 offset:15552
    ds_read_b64_tr_b16 v[158:159], v6 offset:18112
    s_waitcnt lgkmcnt(8)
    v_mfma_f32_32x32x16_bf16 v[160:175], v[128:131], v[120:123], v[160:175]
    v_mfma_f32_32x32x16_bf16 v[176:191], v[132:135], v[120:123], v[176:191]
    v_mfma_f32_32x32x16_bf16 v[192:207], v[136:139], v[120:123], v[192:207]
    v_mfma_f32_32x32x16_bf16 v[208:223], v[140:143], v[120:123], v[208:223]
    s_waitcnt lgkmcnt(0)
    v_mfma_f32_32x32x16_bf16 v[160:175], v[144:147], v[124:127], v[160:175]
    v_mfma_f32_32x32x16_bf16 v[176:191], v[148:151], v[124:127], v[176:191]
    v_mfma_f32_32x32x16_bf16 v[192:207], v[152:155], v[124:127], v[192:207]
    v_mfma_f32_32x32x16_bf16 v[208:223], v[156:159], v[124:127], v[208:223]
    s_add_u32 s34, s33, 1
    s_cmp_ge_u32 s34, s32
    s_cbranch_scc1 nowr_2004
    s_waitcnt vmcnt(0)
    ds_write_b128 v3, v[48:51] offset:0
    ds_write_b128 v4, v[64:67] offset:0
    ds_write_b128 v3, v[52:55] offset:4352
    ds_write_b128 v4, v[68:71] offset:5120
    ds_write_b128 v3, v[56:59] offset:8704
    ds_write_b128 v4, v[72:75] offset:10240
    ds_write_b128 v3, v[60:63] offset:13056
    ds_write_b128 v4, v[76:79] offset:15360
nowr_2004:
    v_add_u32 v5, s38, v5
    v_add_u32 v6, s38, v6
    s_sub_u32 s38, 0, s38
    v_add_u32 v3, s38, v3
    v_add_u32 v4, s38, v4
    s_waitcnt lgkmcnt(0)
    s_barrier
    s_add_u32 s33, s33, 1
    s_cmp_lt_u32 s33, s32
    s_cbranch_scc1 loop_2002
    s_nop 15
    v_mov_b32 v10, v9
    s_nop 1
    v_permlane32_swap_b32 v10, v9
    v_add_f32 v9, v9, v10
    v_rcp_f32 v9, v9
    v_lshlrev_b32 v13, 13, v7
    v_lshl_add_u32 v13, v12, 3, v13
    v_add_u32 v13, s22, v13
    v_mul_f32 v160, v160, v9
    v_mul_f32 v161, v161, v9
    v_mul_f32 v162, v162, v9
    v_mul_f32 v163, v163, v9
    v_mul_f32 v164, v164, v9
    v_mul_f32 v165, v165, v9
    v_mul_f32 v166, v166, v9
    v_mul_f32 v167, v167, v9
    v_mul_f32 v168, v168, v9
    v_mul_f32 v169, v169, v9
    v_mul_f32 v170, v170, v9
    v_mul_f32 v171, v171, v9
    v_mul_f32 v172, v172, v9
    v_mul_f32 v173, v173, v9
    v_mul_f32 v174, v174, v9
    v_mul_f32 v175, v175, v9
    v_mul_f32 v176, v176, v9
    v_mul_f32 v177, v177, v9
    v_mul_f32 v178, v178, v9
    v_mul_f32 v179, v179, v9
    v_mul_f32 v180, v180, v9
    v_mul_f32 v181, v181, v9
    v_mul_f32 v182, v182, v9
    v_mul_f32 v183, v183, v9
    v_mul_f32 v184, v184, v9
    v_mul_f32 v185, v185, v9
    v_mul_f32 v186, v186, v9
    v_mul_f32 v187, v187, v9
    v_mul_f32 v188, v188, v9
    v_mul_f32 v189, v189, v9
    v_mul_f32 v190, v190, v9
    v_mul_f32 v191, v191, v9
    v_mul_f32 v192, v192, v9
    v_mul_f32 v193, v193, v9
    v_mul_f32 v194, v194, v9
    v_mul_f32 v195, v195, v9
    v_mul_f32 v196, v196, v9
    v_mul_f32 v197, v197, v9
    v_mul_f32 v198, v198, v9
    v_mul_f32 v199, v199, v9
    v_mul_f32 v200, v200, v9
    v_mul_f32 v201, v201, v9
    v_mul_f32 v202, v202, v9
    v_mul_f32 v203, v203, v9
    v_mul_f32 v204, v204, v9
    v_mul_f32 v205, v205, v9
    v_mul_f32 v206, v206, v9
    v_mul_f32 v207, v207, v9
    v_mul_f32 v208, v208, v9
    v_mul_f32 v209, v209, v9
    v_mul_f32 v210, v210, v9
    v_mul_f32 v211, v211, v9
    v_mul_f32 v212, v212, v9
    v_mul_f32 v213, v213, v9
    v_mul_f32 v214, v214, v9
    v_mul_f32 v215, v215, v9
    v_mul_f32 v216, v216, v9
    v_mul_f32 v217, v217, v9
    v_mul_f32 v218, v218, v9
    v_mul_f32 v219, v219, v9
    v_mul_f32 v220, v220, v9
    v_mul_f32 v221, v221, v9
    v_mul_f32 v222, v222, v9
    v_mul_f32 v223, v223, v9
    v_cvt_pk_bf16_f32 v128, v160, v161
    v_cvt_pk_bf16_f32 v129, v162, v163
    buffer_store_dwordx2 v[128:129], v13, s[24:27], 0 offen offset:0
    v_cvt_pk_bf16_f32 v130, v164, v165
    v_cvt_pk_bf16_f32 v131, v166, v167
    buffer_store_dwordx2 v[130:131], v13, s[24:27], 0 offen offset:16
    v_cvt_pk_bf16_f32 v132, v168, v169
    v_cvt_pk_bf16_f32 v133, v170, v171
    buffer_store_dwordx2 v[132:133], v13, s[24:27], 0 offen offset:32
    v_cvt_pk_bf16_f32 v134, v172, v173
    v_cvt_pk_bf16_f32 v135, v174, v175
    buffer_store_dwordx2 v[134:135], v13, s[24:27], 0 offen offset:48
    v_cvt_pk_bf16_f32 v136, v176, v177
    v_cvt_pk_bf16_f32 v137, v178, v179
    buffer_store_dwordx2 v[136:137], v13, s[24:27], 0 offen offset:64
    v_cvt_pk_bf16_f32 v138, v180, v181
    v_cvt_pk_bf16_f32 v139, v182, v183
    buffer_store_dwordx2 v[138:139], v13, s[24:27], 0 offen offset:80
    v_cvt_pk_bf16_f32 v140, v184, v185
    v_cvt_pk_bf16_f32 v141, v186, v187
    buffer_store_dwordx2 v[140:141], v13, s[24:27], 0 offen offset:96
    v_cvt_pk_bf16_f32 v142, v188, v189
    v_cvt_pk_bf16_f32 v143, v190, v191
    buffer_store_dwordx2 v[142:143], v13, s[24:27], 0 offen offset:112
    v_cvt_pk_bf16_f32 v144, v192, v193
    v_cvt_pk_bf16_f32 v145, v194, v195
    buffer_store_dwordx2 v[144:145], v13, s[24:27], 0 offen offset:128
    v_cvt_pk_bf16_f32 v146, v196, v197
    v_cvt_pk_bf16_f32 v147, v198, v199
    buffer_store_dwordx2 v[146:147], v13, s[24:27], 0 offen offset:144
    v_cvt_pk_bf16_f32 v148, v200, v201
    v_cvt_pk_bf16_f32 v149, v202, v203
    buffer_store_dwordx2 v[148:149], v13, s[24:27], 0 offen offset:160
    v_cvt_pk_bf16_f32 v150, v204, v205
    v_cvt_pk_bf16_f32 v151, v206, v207
    buffer_store_dwordx2 v[150:151], v13, s[24:27], 0 offen offset:176
    v_cvt_pk_bf16_f32 v152, v208, v209
    v_cvt_pk_bf16_f32 v153, v210, v211
    buffer_store_dwordx2 v[152:153], v13, s[24:27], 0 offen offset:192
    v_cvt_pk_bf16_f32 v154, v212, v213
    v_cvt_pk_bf16_f32 v155, v214, v215
    buffer_store_dwordx2 v[154:155], v13, s[24:27], 0 offen offset:208
    v_cvt_pk_bf16_f32 v156, v216, v217
    v_cvt_pk_bf16_f32 v157, v218, v219
    buffer_store_dwordx2 v[156:157], v13, s[24:27], 0 offen offset:224
    v_cvt_pk_bf16_f32 v158, v220, v221
    v_cvt_pk_bf16_f32 v159, v222, v223
    buffer_store_dwordx2 v[158:159], v13, s[24:27], 0 offen offset:240
done_2001:
    s_endpgm
attna_part:
    s_sub_u32 s2, s2, 512
    s_load_dwordx2 s[4:5], s[0:1], 104
    s_cmp_ge_u32 s2, 512
    s_cbranch_scc1 done_3001
    s_waitcnt lgkmcnt(0)
    s_add_u32 s8, s4, 50331648
    s_addc_u32 s9, s5, 0
    s_mov_b32 s10, 2097152
    s_mov_b32 s11, 0x00020000
    s_add_u32 s12, s4, 52428800
    s_addc_u32 s13, s5, 0
    s_mov_b32 s14, 65536
    s_mov_b32 s15, 0x00020000
    s_add_u32 s16, s4, 53477376
    s_addc_u32 s17, s5, 0
    s_mov_b32 s18, 65536
    s_mov_b32 s19, 0x00020000
    s_add_u32 s24, s4, 54525952
    s_addc_u32 s25, s5, 0
    s_mov_b32 s26, 2097152
    s_mov_b32 s27, 0x00020000
    v_lshrrev_b32 v11, 6, v0
    s_nop 1
    v_readfirstlane_b32 s23, v11
    s_lshl_b32 s20, s2, 2
    s_add_u32 s20, s20, s23
    s_lshr_b32 s21, s20, 6
    s_and_b32 s22, s20, 63
    v_and_b32 v11, 31, v0
    v_bfe_u32 v12, v0, 5, 1
    s_lshl_b32 s22, s22, 5
    v_add_u32 v3, s22, v11
    s_lshl_b32 s21, s21, 5
    v_lshlrev_b32 v13, 10, v3
    v_lshl_add_u32 v13, v12, 4, v13
    v_add_u32 v13, s21, v13
    buffer_load_dwordx4 v[16:19], v13, s[8:11], 0 offen
    v_lshlrev_b32 v1, 5, v11
    v_lshl_add_u32 v1, v12, 4, v1
    v_bfe_u32 v13, v0, 2, 2
    v_lshl_add_u32 v13, v12, 2, v13
    v_lshlrev_b32 v2, 6, v13
    v_bfe_u32 v13, v0, 4, 1
    v_lshl_add_u32 v2, v13, 5, v2
    v_and_b32 v13, 3, v0
    v_lshl_add_u32 v2, v13, 3, v2
    v_add_u32 v2, 16384, v2
    v_mov_b32 v4, 0xf149f2ca
    v_mov_b32 v112, 0
    v_mov_b32 v113, 0
    v_mov_b32 v114, 0
    v_mov_b32 v115, 0
    v_mov_b32 v116, 0
    v_mov_b32 v117, 0
    v_mov_b32 v118, 0
    v_mov_b32 v119, 0
    v_mov_b32 v120, 0
    v_mov_b32 v121, 0
    v_mov_b32 v122, 0
    v_mov_b32 v123, 0
    v_mov_b32 v124, 0
    v_mov_b32 v125, 0
    v_mov_b32 v126, 0
    v_mov_b32 v127, 0
    s_mov_b32 s31, 1052289595
    v_mov_b32 v9, 0x3f80
    v_mov_b32 v21, 0
    v_mov_b32 v22, 0
    v_mov_b32 v23, 0
    s_barrier
    v_lshlrev_b32 v13, 4, v0
    s_mov_b32 s40, 0
    buffer_load_dwordx4 v[80:83], v13, s[12:15], s40 offen
    buffer_load_dwordx4 v[96:99], v13, s[16:19], s40 offen
    s_mov_b32 s40, 4096
    buffer_load_dwordx4 v[84:87], v13, s[12:15], s40 offen
    buffer_load_dwordx4 v[100:103], v13, s[16:19], s40 offen
    s_mov_b32 s40, 8192
    buffer_load_dwordx4 v[88:91], v13, s[12:15], s40 offen
    buffer_load_dwordx4 v[104:107], v13, s[16:19], s40 offen
    s_mov_b32 s40, 12288
    buffer_load_dwordx4 v[92:95], v13, s[12:15], s40 offen
    buffer_load_dwordx4 v[108:111], v13, s[16:19], s40 offen
    v_lshrrev_b32 v14, 1, v0
    v_lshlrev_b32 v14, 6, v14
    v_and_b32 v15, 1, v0
    v_lshl_add_u32 v14, v15, 4, v14
    v_add_u32 v14, 16384, v14
    s_waitcnt vmcnt(0)
    ds_write_b128 v13, v[80:83] offset:0
    ds_write_b128 v14, v[96:99] offset:0
    ds_write_b128 v13, v[84:87] offset:4096
    ds_write_b128 v14, v[100:103] offset:8192
    ds_write_b128 v13, v[88:91] offset:8192
    ds_write_b128 v14, v[104:107] offset:16384
    ds_write_b128 v13, v[92:95] offset:12288
    ds_write_b128 v14, v[108:111] offset:24576
    v_cmp_eq_u32 vcc, 0, v15
    s_nop 1
    v_cndmask_b32 v20, 0, v9, vcc
    ds_write_b128 v14, v[20:23] offset:32
    ds_write_b128 v14, v[20:23] offset:8224
    ds_write_b128 v14, v[20:23] offset:16416
    ds_write_b128 v14, v[20:23] offset:24608
    s_waitcnt lgkmcnt(0)
    s_barrier
    s_mov_b32 s33, 0
loop_3002:
    v_add_u32 v13, s33, v1
    s_lshl_b32 s34, s33, 1
    v_add_u32 v14, s34, v2
    ds_read_b128 v[80:83], v13 offset:0
    ds_read_b128 v[84:87], v13 offset:1024
    ds_read_b64_tr_b16 v[88:89], v14 offset:0
    ds_read_b64_tr_b16 v[90:91], v14 offset:512
    ds_read_b64_tr_b16 v[92:93], v14 offset:1024
    ds_read_b64_tr_b16 v[94:95], v14 offset:1536
    ds_read_b64_tr_b16 v[96:97], v14 offset:2048
    ds_read_b64_tr_b16 v[98:99], v14 offset:2560
    ds_read_b64_tr_b16 v[100:101], v14 offset:3072
    ds_read_b64_tr_b16 v[102:103], v14 offset:3584
    s_waitcnt lgkmcnt(9)
    v_mfma_f32_32x32x16_bf16 v[32:47], v[80:83], v[16:19], 0
    s_waitcnt lgkmcnt(8)
    v_mfma_f32_32x32x16_bf16 v[48:63], v[84:87], v[16:19], 0
    s_nop 15
    v_max3_f32 v6, v32, v33, v34
    v_max3_f32 v6, v6, v35, v36
    v_max3_f32 v6, v6, v37, v38
    v_max3_f32 v6, v6, v39, v40
    v_max3_f32 v6, v6, v41, v42
    v_max3_f32 v6, v6, v43, v44
    v_max3_f32 v6, v6, v45, v46
    v_max3_f32 v6, v6, v47, v48
    v_max3_f32 v6, v6, v49, v50
    v_max3_f32 v6, v6, v51, v52
    v_max3_f32 v6, v6, v53, v54
    v_max3_f32 v6, v6, v55, v56
    v_max3_f32 v6, v6, v57, v58
    v_max3_f32 v6, v6, v59, v60
    v_max3_f32 v6, v6, v61, v62
    v_max_f32 v6, v6, v63
    v_mov_b32 v7, v6
    s_nop 1
    v_permlane32_swap_b32 v6, v7
    v_max_f32 v6, v6, v7
    v_max_f32 v6, v6, v4
    v_cmp_gt_f32 vcc, v6, v4
    v_sub_f32 v7, v4, v6
    v_mul_f32 v7, s31, v7
    v_exp_f32 v7, v7
    v_mov_b32 v4, v6
    v_mul_f32 v6, s31, v6
    v_fma_f32 v32, v32, s31, -v6
    v_fma_f32 v33, v33, s31, -v6
    v_fma_f32 v34, v34, s31, -v6
    v_fma_f32 v35, v35, s31, -v6
    v_fma_f32 v36, v36, s31, -v6
    v_fma_f32 v37, v37, s31, -v6
    v_fma_f32 v38, v38, s31, -v6
    v_fma_f32 v39, v39, s31, -v6
    v_fma_f32 v40, v40, s31, -v6
    v_fma_f32 v41, v41, s31, -v6
    v_fma_f32 v42, v42, s31, -v6
    v_fma_f32 v43, v43, s31, -v6
    v_fma_f32 v44, v44, s31, -v6
    v_fma_f32 v45, v45, s31, -v6
    v_fma_f32 v46, v46, s31, -v6
    v_fma_f32 v47, v47, s31, -v6
    v_fma_f32 v48, v48, s31, -v6
    v_fma_f32 v49, v49, s31, -v6
    v_fma_f32 v50, v50, s31, -v6
    v_fma_f32 v51, v51, s31, -v6
    v_fma_f32 v52, v52, s31, -v6
    v_fma_f32 v53, v53, s31, -v6
    v_fma_f32 v54, v54, s31, -v6
    v_fma_f32 v55, v55, s31, -v6
    v_fma_f32 v56, v56, s31, -v6
    v_fma_f32 v57, v57, s31, -v6
    v_fma_f32 v58, v58, s31, -v6
    v_fma_f32 v59, v59, s31, -v6
    v_fma_f32 v60, v60, s31, -v6
    v_fma_f32 v61, v61, s31, -v6
    v_fma_f32 v62, v62, s31, -v6
    v_fma_f32 v63, v63, s31, -v6
    v_exp_f32 v32, v32
    v_exp_f32 v33, v33
    v_exp_f32 v34, v34
    v_exp_f32 v35, v35
    v_exp_f32 v36, v36
    v_exp_f32 v37, v37
    v_exp_f32 v38, v38
    v_exp_f32 v39, v39
    v_exp_f32 v40, v40
    v_exp_f32 v41, v41
    v_exp_f32 v42, v42
    v_exp_f32 v43, v43
    v_exp_f32 v44, v44
    v_exp_f32 v45, v45
    v_exp_f32 v46, v46
    v_exp_f32 v47, v47
    v_exp_f32 v48, v48
    v_exp_f32 v49, v49
    v_exp_f32 v50, v50
    v_exp_f32 v51, v51
    v_exp_f32 v52, v52
    v_exp_f32 v53, v53
    v_exp_f32 v54, v54
    v_exp_f32 v55, v55
    v_exp_f32 v56, v56
    v_exp_f32 v57, v57
    v_exp_f32 v58, v58
    v_exp_f32 v59, v59
    v_exp_f32 v60, v60
    v_exp_f32 v61, v61
    v_exp_f32 v62, v62
    v_exp_f32 v63, v63
    s_cbranch_vccz norescale_3003
    v_mul_f32 v112, v112, v7
    v_mul_f32 v113, v113, v7
    v_mul_f32 v114, v114, v7
    v_mul_f32 v115, v115, v7
    v_mul_f32 v116, v116, v7
    v_mul_f32 v117, v117, v7
    v_mul_f32 v118, v118, v7
    v_mul_f32 v119, v119, v7
    v_mul_f32 v120, v120, v7
    v_mul_f32 v121, v121, v7
    v_mul_f32 v122, v122, v7
    v_mul_f32 v123, v123, v7
    v_mul_f32 v124, v124, v7
    v_mul_f32 v125, v125, v7
    v_mul_f32 v126, v126, v7
    v_mul_f32 v127, v127, v7
norescale_3003:
    v_cvt_pk_bf16_f32 v64, v32, v33
    v_cvt_pk_bf16_f32 v65, v34, v35
    v_cvt_pk_bf16_f32 v66, v36, v37
    v_cvt_pk_bf16_f32 v67, v38, v39
    v_cvt_pk_bf16_f32 v68, v40, v41
    v_cvt_pk_bf16_f32 v69, v42, v43
    v_cvt_pk_bf16_f32 v70, v44, v45
    v_cvt_pk_bf16_f32 v71, v46, v47
    v_cvt_pk_bf16_f32 v72, v48, v49
    v_cvt_pk_bf16_f32 v73, v50, v51
    v_cvt_pk_bf16_f32 v74, v52, v53
    v_cvt_pk_bf16_f32 v75, v54, v55
    v_cvt_pk_bf16_f32 v76, v56, v57
    v_cvt_pk_bf16_f32 v77, v58, v59
    v_cvt_pk_bf16_f32 v78, v60, v61
    v_cvt_pk_bf16_f32 v79, v62, v63
    s_waitcnt lgkmcnt(0)
    v_mfma_f32_32x32x16_bf16 v[112:127], v[88:91], v[64:67], v[112:127]
    v_mfma_f32_32x32x16_bf16 v[112:127], v[92:95], v[68:71], v[112:127]
    v_mfma_f32_32x32x16_bf16 v[112:127], v[96:99], v[72:75], v[112:127]
    v_mfma_f32_32x32x16_bf16 v[112:127], v[100:103], v[76:79], v[112:127]
    s_add_u32 s33, s33, 2048
    s_cmp_lt_u32 s33, 16384
    s_cbranch_scc1 loop_3002
    s_barrier
    v_lshlrev_b32 v13, 4, v0
    s_mov_b32 s40, 16384
    buffer_load_dwordx4 v[80:83], v13, s[12:15], s40 offen
    buffer_load_dwordx4 v[96:99], v13, s[16:19], s40 offen
    s_mov_b32 s40, 20480
    buffer_load_dwordx4 v[84:87], v13, s[12:15], s40 offen
    buffer_load_dwordx4 v[100:103], v13, s[16:19], s40 offen
    s_mov_b32 s40, 24576
    buffer_load_dwordx4 v[88:91], v13, s[12:15], s40 offen
    buffer_load_dwordx4 v[104:107], v13, s[16:19], s40 offen
    s_mov_b32 s40, 28672
    buffer_load_dwordx4 v[92:95], v13, s[12:15], s40 offen
    buffer_load_dwordx4 v[108:111], v13, s[16:19], s40 offen
    v_lshrrev_b32 v14, 1, v0
    v_lshlrev_b32 v14, 6, v14
    v_and_b32 v15, 1, v0
    v_lshl_add_u32 v14, v15, 4, v14
    v_add_u32 v14, 16384, v14
    s_waitcnt vmcnt(0)
    ds_write_b128 v13, v[80:83] offset:0
    ds_write_b128 v14, v[96:99] offset:0
    ds_write_b128 v13, v[84:87] offset:4096
    ds_write_b128 v14, v[100:103] offset:8192
    ds_write_b128 v13, v[88:91] offset:8192
    ds_write_b128 v14, v[104:107] offset:16384
    ds_write_b128 v13, v[92:95] offset:12288
    ds_write_b128 v14, v[108:111] offset:24576
    v_cmp_eq_u32 vcc, 0, v15
    s_nop 1
    v_cndmask_b32 v20, 0, v9, vcc
    ds_write_b128 v14, v[20:23] offset:32
    ds_write_b128 v14, v[20:23] offset:8224
    ds_write_b128 v14, v[20:23] offset:16416
    ds_write_b128 v14, v[20:23] offset:24608
    s_waitcnt lgkmcnt(0)
    s_barrier
    s_mov_b32 s33, 0
loop_3004:
    v_add_u32 v13, s33, v1
    s_lshl_b32 s34, s33, 1
    v_add_u32 v14, s34, v2
    ds_read_b128 v[80:83], v13 offset:0
    ds_read_b128 v[84:87], v13 offset:1024
    ds_read_b64_tr_b16 v[88:89], v14 offset:0
    ds_read_b64_tr_b16 v[90:91], v14 offset:512
    ds_read_b64_tr_b16 v[92:93], v14 offset:1024
    ds_read_b64_tr_b16 v[94:95], v14 offset:1536
    ds_read_b64_tr_b16 v[96:97], v14 offset:2048
    ds_read_b64_tr_b16 v[98:99], v14 offset:2560
    ds_read_b64_tr_b16 v[100:101], v14 offset:3072
    ds_read_b64_tr_b16 v[102:103], v14 offset:3584
    s_waitcnt lgkmcnt(9)
    v_mfma_f32_32x32x16_bf16 v[32:47], v[80:83], v[16:19], 0
    s_waitcnt lgkmcnt(8)
    v_mfma_f32_32x32x16_bf16 v[48:63], v[84:87], v[16:19], 0
    s_nop 15
    v_max3_f32 v6, v32, v33, v34
    v_max3_f32 v6, v6, v35, v36
    v_max3_f32 v6, v6, v37, v38
    v_max3_f32 v6, v6, v39, v40
    v_max3_f32 v6, v6, v41, v42
    v_max3_f32 v6, v6, v43, v44
    v_max3_f32 v6, v6, v45, v46
    v_max3_f32 v6, v6, v47, v48
    v_max3_f32 v6, v6, v49, v50
    v_max3_f32 v6, v6, v51, v52
    v_max3_f32 v6, v6, v53, v54
    v_max3_f32 v6, v6, v55, v56
    v_max3_f32 v6, v6, v57, v58
    v_max3_f32 v6, v6, v59, v60
    v_max3_f32 v6, v6, v61, v62
    v_max_f32 v6, v6, v63
    v_mov_b32 v7, v6
    s_nop 1
    v_permlane32_swap_b32 v6, v7
    v_max_f32 v6, v6, v7
    v_max_f32 v6, v6, v4
    v_cmp_gt_f32 vcc, v6, v4
    v_sub_f32 v7, v4, v6
    v_mul_f32 v7, s31, v7
    v_exp_f32 v7, v7
    v_mov_b32 v4, v6
    v_mul_f32 v6, s31, v6
    v_fma_f32 v32, v32, s31, -v6
    v_fma_f32 v33, v33, s31, -v6
    v_fma_f32 v34, v34, s31, -v6
    v_fma_f32 v35, v35, s31, -v6
    v_fma_f32 v36, v36, s31, -v6
    v_fma_f32 v37, v37, s31, -v6
    v_fma_f32 v38, v38, s31, -v6
    v_fma_f32 v39, v39, s31, -v6
    v_fma_f32 v40, v40, s31, -v6
    v_fma_f32 v41, v41, s31, -v6
    v_fma_f32 v42, v42, s31, -v6
    v_fma_f32 v43, v43, s31, -v6
    v_fma_f32 v44, v44, s31, -v6
    v_fma_f32 v45, v45, s31, -v6
    v_fma_f32 v46, v46, s31, -v6
    v_fma_f32 v47, v47, s31, -v6
    v_fma_f32 v48, v48, s31, -v6
    v_fma_f32 v49, v49, s31, -v6
    v_fma_f32 v50, v50, s31, -v6
    v_fma_f32 v51, v51, s31, -v6
    v_fma_f32 v52, v52, s31, -v6
    v_fma_f32 v53, v53, s31, -v6
    v_fma_f32 v54, v54, s31, -v6
    v_fma_f32 v55, v55, s31, -v6
    v_fma_f32 v56, v56, s31, -v6
    v_fma_f32 v57, v57, s31, -v6
    v_fma_f32 v58, v58, s31, -v6
    v_fma_f32 v59, v59, s31, -v6
    v_fma_f32 v60, v60, s31, -v6
    v_fma_f32 v61, v61, s31, -v6
    v_fma_f32 v62, v62, s31, -v6
    v_fma_f32 v63, v63, s31, -v6
    v_exp_f32 v32, v32
    v_exp_f32 v33, v33
    v_exp_f32 v34, v34
    v_exp_f32 v35, v35
    v_exp_f32 v36, v36
    v_exp_f32 v37, v37
    v_exp_f32 v38, v38
    v_exp_f32 v39, v39
    v_exp_f32 v40, v40
    v_exp_f32 v41, v41
    v_exp_f32 v42, v42
    v_exp_f32 v43, v43
    v_exp_f32 v44, v44
    v_exp_f32 v45, v45
    v_exp_f32 v46, v46
    v_exp_f32 v47, v47
    v_exp_f32 v48, v48
    v_exp_f32 v49, v49
    v_exp_f32 v50, v50
    v_exp_f32 v51, v51
    v_exp_f32 v52, v52
    v_exp_f32 v53, v53
    v_exp_f32 v54, v54
    v_exp_f32 v55, v55
    v_exp_f32 v56, v56
    v_exp_f32 v57, v57
    v_exp_f32 v58, v58
    v_exp_f32 v59, v59
    v_exp_f32 v60, v60
    v_exp_f32 v61, v61
    v_exp_f32 v62, v62
    v_exp_f32 v63, v63
    s_cbranch_vccz norescale_3005
    v_mul_f32 v112, v112, v7
    v_mul_f32 v113, v113, v7
    v_mul_f32 v114, v114, v7
    v_mul_f32 v115, v115, v7
    v_mul_f32 v116, v116, v7
    v_mul_f32 v117, v117, v7
    v_mul_f32 v118, v118, v7
    v_mul_f32 v119, v119, v7
    v_mul_f32 v120, v120, v7
    v_mul_f32 v121, v121, v7
    v_mul_f32 v122, v122, v7
    v_mul_f32 v123, v123, v7
    v_mul_f32 v124, v124, v7
    v_mul_f32 v125, v125, v7
    v_mul_f32 v126, v126, v7
    v_mul_f32 v127, v127, v7
norescale_3005:
    v_cvt_pk_bf16_f32 v64, v32, v33
    v_cvt_pk_bf16_f32 v65, v34, v35
    v_cvt_pk_bf16_f32 v66, v36, v37
    v_cvt_pk_bf16_f32 v67, v38, v39
    v_cvt_pk_bf16_f32 v68, v40, v41
    v_cvt_pk_bf16_f32 v69, v42, v43
    v_cvt_pk_bf16_f32 v70, v44, v45
    v_cvt_pk_bf16_f32 v71, v46, v47
    v_cvt_pk_bf16_f32 v72, v48, v49
    v_cvt_pk_bf16_f32 v73, v50, v51
    v_cvt_pk_bf16_f32 v74, v52, v53
    v_cvt_pk_bf16_f32 v75, v54, v55
    v_cvt_pk_bf16_f32 v76, v56, v57
    v_cvt_pk_bf16_f32 v77, v58, v59
    v_cvt_pk_bf16_f32 v78, v60, v61
    v_cvt_pk_bf16_f32 v79, v62, v63
    s_waitcnt lgkmcnt(0)
    v_mfma_f32_32x32x16_bf16 v[112:127], v[88:91], v[64:67], v[112:127]
    v_mfma_f32_32x32x16_bf16 v[112:127], v[92:95], v[68:71], v[112:127]
    v_mfma_f32_32x32x16_bf16 v[112:127], v[96:99], v[72:75], v[112:127]
    v_mfma_f32_32x32x16_bf16 v[112:127], v[100:103], v[76:79], v[112:127]
    s_add_u32 s33, s33, 2048
    s_cmp_lt_u32 s33, 16384
    s_cbranch_scc1 loop_3004
    s_barrier
    v_lshlrev_b32 v13, 4, v0
    s_mov_b32 s40, 32768
    buffer_load_dwordx4 v[80:83], v13, s[12:15], s40 offen
    buffer_load_dwordx4 v[96:99], v13, s[16:19], s40 offen
    s_mov_b32 s40, 36864
    buffer_load_dwordx4 v[84:87], v13, s[12:15], s40 offen
    buffer_load_dwordx4 v[100:103], v13, s[16:19], s40 offen
    s_mov_b32 s40, 40960
    buffer_load_dwordx4 v[88:91], v13, s[12:15], s40 offen
    buffer_load_dwordx4 v[104:107], v13, s[16:19], s40 offen
    s_mov_b32 s40, 45056
    buffer_load_dwordx4 v[92:95], v13, s[12:15], s40 offen
    buffer_load_dwordx4 v[108:111], v13, s[16:19], s40 offen
    v_lshrrev_b32 v14, 1, v0
    v_lshlrev_b32 v14, 6, v14
    v_and_b32 v15, 1, v0
    v_lshl_add_u32 v14, v15, 4, v14
    v_add_u32 v14, 16384, v14
    s_waitcnt vmcnt(0)
    ds_write_b128 v13, v[80:83] offset:0
    ds_write_b128 v14, v[96:99] offset:0
    ds_write_b128 v13, v[84:87] offset:4096
    ds_write_b128 v14, v[100:103] offset:8192
    ds_write_b128 v13, v[88:91] offset:8192
    ds_write_b128 v14, v[104:107] offset:16384
    ds_write_b128 v13, v[92:95] offset:12288
    ds_write_b128 v14, v[108:111] offset:24576
    v_cmp_eq_u32 vcc, 0, v15
    s_nop 1
    v_cndmask_b32 v20, 0, v9, vcc
    ds_write_b128 v14, v[20:23] offset:32
    ds_write_b128 v14, v[20:23] offset:8224
    ds_write_b128 v14, v[20:23] offset:16416
    ds_write_b128 v14, v[20:23] offset:24608
    s_waitcnt lgkmcnt(0)
    s_barrier
    s_mov_b32 s33, 0
loop_3006:
    v_add_u32 v13, s33, v1
    s_lshl_b32 s34, s33, 1
    v_add_u32 v14, s34, v2
    ds_read_b128 v[80:83], v13 offset:0
    ds_read_b128 v[84:87], v13 offset:1024
    ds_read_b64_tr_b16 v[88:89], v14 offset:0
    ds_read_b64_tr_b16 v[90:91], v14 offset:512
    ds_read_b64_tr_b16 v[92:93], v14 offset:1024
    ds_read_b64_tr_b16 v[94:95], v14 offset:1536
    ds_read_b64_tr_b16 v[96:97], v14 offset:2048
    ds_read_b64_tr_b16 v[98:99], v14 offset:2560
    ds_read_b64_tr_b16 v[100:101], v14 offset:3072
    ds_read_b64_tr_b16 v[102:103], v14 offset:3584
    s_waitcnt lgkmcnt(9)
    v_mfma_f32_32x32x16_bf16 v[32:47], v[80:83], v[16:19], 0
    s_waitcnt lgkmcnt(8)
    v_mfma_f32_32x32x16_bf16 v[48:63], v[84:87], v[16:19], 0
    s_nop 15
    v_max3_f32 v6, v32, v33, v34
    v_max3_f32 v6, v6, v35, v36
    v_max3_f32 v6, v6, v37, v38
    v_max3_f32 v6, v6, v39, v40
    v_max3_f32 v6, v6, v41, v42
    v_max3_f32 v6, v6, v43, v44
    v_max3_f32 v6, v6, v45, v46
    v_max3_f32 v6, v6, v47, v48
    v_max3_f32 v6, v6, v49, v50
    v_max3_f32 v6, v6, v51, v52
    v_max3_f32 v6, v6, v53, v54
    v_max3_f32 v6, v6, v55, v56
    v_max3_f32 v6, v6, v57, v58
    v_max3_f32 v6, v6, v59, v60
    v_max3_f32 v6, v6, v61, v62
    v_max_f32 v6, v6, v63
    v_mov_b32 v7, v6
    s_nop 1
    v_permlane32_swap_b32 v6, v7
    v_max_f32 v6, v6, v7
    v_max_f32 v6, v6, v4
    v_cmp_gt_f32 vcc, v6, v4
    v_sub_f32 v7, v4, v6
    v_mul_f32 v7, s31, v7
    v_exp_f32 v7, v7
    v_mov_b32 v4, v6
    v_mul_f32 v6, s31, v6
    v_fma_f32 v32, v32, s31, -v6
    v_fma_f32 v33, v33, s31, -v6
    v_fma_f32 v34, v34, s31, -v6
    v_fma_f32 v35, v35, s31, -v6
    v_fma_f32 v36, v36, s31, -v6
    v_fma_f32 v37, v37, s31, -v6
    v_fma_f32 v38, v38, s31, -v6
    v_fma_f32 v39, v39, s31, -v6
    v_fma_f32 v40, v40, s31, -v6
    v_fma_f32 v41, v41, s31, -v6
    v_fma_f32 v42, v42, s31, -v6
    v_fma_f32 v43, v43, s31, -v6
    v_fma_f32 v44, v44, s31, -v6
    v_fma_f32 v45, v45, s31, -v6
    v_fma_f32 v46, v46, s31, -v6
    v_fma_f32 v47, v47, s31, -v6
    v_fma_f32 v48, v48, s31, -v6
    v_fma_f32 v49, v49, s31, -v6
    v_fma_f32 v50, v50, s31, -v6
    v_fma_f32 v51, v51, s31, -v6
    v_fma_f32 v52, v52, s31, -v6
    v_fma_f32 v53, v53, s31, -v6
    v_fma_f32 v54, v54, s31, -v6
    v_fma_f32 v55, v55, s31, -v6
    v_fma_f32 v56, v56, s31, -v6
    v_fma_f32 v57, v57, s31, -v6
    v_fma_f32 v58, v58, s31, -v6
    v_fma_f32 v59, v59, s31, -v6
    v_fma_f32 v60, v60, s31, -v6
    v_fma_f32 v61, v61, s31, -v6
    v_fma_f32 v62, v62, s31, -v6
    v_fma_f32 v63, v63, s31, -v6
    v_exp_f32 v32, v32
    v_exp_f32 v33, v33
    v_exp_f32 v34, v34
    v_exp_f32 v35, v35
    v_exp_f32 v36, v36
    v_exp_f32 v37, v37
    v_exp_f32 v38, v38
    v_exp_f32 v39, v39
    v_exp_f32 v40, v40
    v_exp_f32 v41, v41
    v_exp_f32 v42, v42
    v_exp_f32 v43, v43
    v_exp_f32 v44, v44
    v_exp_f32 v45, v45
    v_exp_f32 v46, v46
    v_exp_f32 v47, v47
    v_exp_f32 v48, v48
    v_exp_f32 v49, v49
    v_exp_f32 v50, v50
    v_exp_f32 v51, v51
    v_exp_f32 v52, v52
    v_exp_f32 v53, v53
    v_exp_f32 v54, v54
    v_exp_f32 v55, v55
    v_exp_f32 v56, v56
    v_exp_f32 v57, v57
    v_exp_f32 v58, v58
    v_exp_f32 v59, v59
    v_exp_f32 v60, v60
    v_exp_f32 v61, v61
    v_exp_f32 v62, v62
    v_exp_f32 v63, v63
    s_cbranch_vccz norescale_3007
    v_mul_f32 v112, v112, v7
    v_mul_f32 v113, v113, v7
    v_mul_f32 v114, v114, v7
    v_mul_f32 v115, v115, v7
    v_mul_f32 v116, v116, v7
    v_mul_f32 v117, v117, v7
    v_mul_f32 v118, v118, v7
    v_mul_f32 v119, v119, v7
    v_mul_f32 v120, v120, v7
    v_mul_f32 v121, v121, v7
    v_mul_f32 v122, v122, v7
    v_mul_f32 v123, v123, v7
    v_mul_f32 v124, v124, v7
    v_mul_f32 v125, v125, v7
    v_mul_f32 v126, v126, v7
    v_mul_f32 v127, v127, v7
norescale_3007:
    v_cvt_pk_bf16_f32 v64, v32, v33
    v_cvt_pk_bf16_f32 v65, v34, v35
    v_cvt_pk_bf16_f32 v66, v36, v37
    v_cvt_pk_bf16_f32 v67, v38, v39
    v_cvt_pk_bf16_f32 v68, v40, v41
    v_cvt_pk_bf16_f32 v69, v42, v43
    v_cvt_pk_bf16_f32 v70, v44, v45
    v_cvt_pk_bf16_f32 v71, v46, v47
    v_cvt_pk_bf16_f32 v72, v48, v49
    v_cvt_pk_bf16_f32 v73, v50, v51
    v_cvt_pk_bf16_f32 v74, v52, v53
    v_cvt_pk_bf16_f32 v75, v54, v55
    v_cvt_pk_bf16_f32 v76, v56, v57
    v_cvt_pk_bf16_f32 v77, v58, v59
    v_cvt_pk_bf16_f32 v78, v60, v61
    v_cvt_pk_bf16_f32 v79, v62, v63
    s_waitcnt lgkmcnt(0)
    v_mfma_f32_32x32x16_bf16 v[112:127], v[88:91], v[64:67], v[112:127]
    v_mfma_f32_32x32x16_bf16 v[112:127], v[92:95], v[68:71], v[112:127]
    v_mfma_f32_32x32x16_bf16 v[112:127], v[96:99], v[72:75], v[112:127]
    v_mfma_f32_32x32x16_bf16 v[112:127], v[100:103], v[76:79], v[112:127]
    s_add_u32 s33, s33, 2048
    s_cmp_lt_u32 s33, 16384
    s_cbranch_scc1 loop_3006
    s_barrier
    v_lshlrev_b32 v13, 4, v0
    s_mov_b32 s40, 49152
    buffer_load_dwordx4 v[80:83], v13, s[12:15], s40 offen
    buffer_load_dwordx4 v[96:99], v13, s[16:19], s40 offen
    s_mov_b32 s40, 53248
    buffer_load_dwordx4 v[84:87], v13, s[12:15], s40 offen
    buffer_load_dwordx4 v[100:103], v13, s[16:19], s40 offen
    s_mov_b32 s40, 57344
    buffer_load_dwordx4 v[88:91], v13, s[12:15], s40 offen
    buffer_load_dwordx4 v[104:107], v13, s[16:19], s40 offen
    s_mov_b32 s40, 61440
    buffer_load_dwordx4 v[92:95], v13, s[12:15], s40 offen
    buffer_load_dwordx4 v[108:111], v13, s[16:19], s40 offen
    v_lshrrev_b32 v14, 1, v0
    v_lshlrev_b32 v14, 6, v14
    v_and_b32 v15, 1, v0
    v_lshl_add_u32 v14, v15, 4, v14
    v_add_u32 v14, 16384, v14
    s_waitcnt vmcnt(0)
    ds_write_b128 v13, v[80:83] offset:0
    ds_write_b128 v14, v[96:99] offset:0
    ds_write_b128 v13, v[84:87] offset:4096
    ds_write_b128 v14, v[100:103] offset:8192
    ds_write_b128 v13, v[88:91] offset:8192
    ds_write_b128 v14, v[104:107] offset:16384
    ds_write_b128 v13, v[92:95] offset:12288
    ds_write_b128 v14, v[108:111] offset:24576
    v_cmp_eq_u32 vcc, 0, v15
    s_nop 1
    v_cndmask_b32 v20, 0, v9, vcc
    ds_write_b128 v14, v[20:23] offset:32
    ds_write_b128 v14, v[20:23] offset:8224
    ds_write_b128 v14, v[20:23] offset:16416
    ds_write_b128 v14, v[20:23] offset:24608
    s_waitcnt lgkmcnt(0)
    s_barrier
    s_mov_b32 s33, 0
loop_3008:
    v_add_u32 v13, s33, v1
    s_lshl_b32 s34, s33, 1
    v_add_u32 v14, s34, v2
    ds_read_b128 v[80:83], v13 offset:0
    ds_read_b128 v[84:87], v13 offset:1024
    ds_read_b64_tr_b16 v[88:89], v14 offset:0
    ds_read_b64_tr_b16 v[90:91], v14 offset:512
    ds_read_b64_tr_b16 v[92:93], v14 offset:1024
    ds_read_b64_tr_b16 v[94:95], v14 offset:1536
    ds_read_b64_tr_b16 v[96:97], v14 offset:2048
    ds_read_b64_tr_b16 v[98:99], v14 offset:2560
    ds_read_b64_tr_b16 v[100:101], v14 offset:3072
    ds_read_b64_tr_b16 v[102:103], v14 offset:3584
    s_waitcnt lgkmcnt(9)
    v_mfma_f32_32x32x16_bf16 v[32:47], v[80:83], v[16:19], 0
    s_waitcnt lgkmcnt(8)
    v_mfma_f32_32x32x16_bf16 v[48:63], v[84:87], v[16:19], 0
    s_nop 15
    v_max3_f32 v6, v32, v33, v34
    v_max3_f32 v6, v6, v35, v36
    v_max3_f32 v6, v6, v37, v38
    v_max3_f32 v6, v6, v39, v40
    v_max3_f32 v6, v6, v41, v42
    v_max3_f32 v6, v6, v43, v44
    v_max3_f32 v6, v6, v45, v46
    v_max3_f32 v6, v6, v47, v48
    v_max3_f32 v6, v6, v49, v50
    v_max3_f32 v6, v6, v51, v52
    v_max3_f32 v6, v6, v53, v54
    v_max3_f32 v6, v6, v55, v56
    v_max3_f32 v6, v6, v57, v58
    v_max3_f32 v6, v6, v59, v60
    v_max3_f32 v6, v6, v61, v62
    v_max_f32 v6, v6, v63
    v_mov_b32 v7, v6
    s_nop 1
    v_permlane32_swap_b32 v6, v7
    v_max_f32 v6, v6, v7
    v_max_f32 v6, v6, v4
    v_cmp_gt_f32 vcc, v6, v4
    v_sub_f32 v7, v4, v6
    v_mul_f32 v7, s31, v7
    v_exp_f32 v7, v7
    v_mov_b32 v4, v6
    v_mul_f32 v6, s31, v6
    v_fma_f32 v32, v32, s31, -v6
    v_fma_f32 v33, v33, s31, -v6
    v_fma_f32 v34, v34, s31, -v6
    v_fma_f32 v35, v35, s31, -v6
    v_fma_f32 v36, v36, s31, -v6
    v_fma_f32 v37, v37, s31, -v6
    v_fma_f32 v38, v38, s31, -v6
    v_fma_f32 v39, v39, s31, -v6
    v_fma_f32 v40, v40, s31, -v6
    v_fma_f32 v41, v41, s31, -v6
    v_fma_f32 v42, v42, s31, -v6
    v_fma_f32 v43, v43, s31, -v6
    v_fma_f32 v44, v44, s31, -v6
    v_fma_f32 v45, v45, s31, -v6
    v_fma_f32 v46, v46, s31, -v6
    v_fma_f32 v47, v47, s31, -v6
    v_fma_f32 v48, v48, s31, -v6
    v_fma_f32 v49, v49, s31, -v6
    v_fma_f32 v50, v50, s31, -v6
    v_fma_f32 v51, v51, s31, -v6
    v_fma_f32 v52, v52, s31, -v6
    v_fma_f32 v53, v53, s31, -v6
    v_fma_f32 v54, v54, s31, -v6
    v_fma_f32 v55, v55, s31, -v6
    v_fma_f32 v56, v56, s31, -v6
    v_fma_f32 v57, v57, s31, -v6
    v_fma_f32 v58, v58, s31, -v6
    v_fma_f32 v59, v59, s31, -v6
    v_fma_f32 v60, v60, s31, -v6
    v_fma_f32 v61, v61, s31, -v6
    v_fma_f32 v62, v62, s31, -v6
    v_fma_f32 v63, v63, s31, -v6
    v_exp_f32 v32, v32
    v_exp_f32 v33, v33
    v_exp_f32 v34, v34
    v_exp_f32 v35, v35
    v_exp_f32 v36, v36
    v_exp_f32 v37, v37
    v_exp_f32 v38, v38
    v_exp_f32 v39, v39
    v_exp_f32 v40, v40
    v_exp_f32 v41, v41
    v_exp_f32 v42, v42
    v_exp_f32 v43, v43
    v_exp_f32 v44, v44
    v_exp_f32 v45, v45
    v_exp_f32 v46, v46
    v_exp_f32 v47, v47
    v_exp_f32 v48, v48
    v_exp_f32 v49, v49
    v_exp_f32 v50, v50
    v_exp_f32 v51, v51
    v_exp_f32 v52, v52
    v_exp_f32 v53, v53
    v_exp_f32 v54, v54
    v_exp_f32 v55, v55
    v_exp_f32 v56, v56
    v_exp_f32 v57, v57
    v_exp_f32 v58, v58
    v_exp_f32 v59, v59
    v_exp_f32 v60, v60
    v_exp_f32 v61, v61
    v_exp_f32 v62, v62
    v_exp_f32 v63, v63
    s_cbranch_vccz norescale_3009
    v_mul_f32 v112, v112, v7
    v_mul_f32 v113, v113, v7
    v_mul_f32 v114, v114, v7
    v_mul_f32 v115, v115, v7
    v_mul_f32 v116, v116, v7
    v_mul_f32 v117, v117, v7
    v_mul_f32 v118, v118, v7
    v_mul_f32 v119, v119, v7
    v_mul_f32 v120, v120, v7
    v_mul_f32 v121, v121, v7
    v_mul_f32 v122, v122, v7
    v_mul_f32 v123, v123, v7
    v_mul_f32 v124, v124, v7
    v_mul_f32 v125, v125, v7
    v_mul_f32 v126, v126, v7
    v_mul_f32 v127, v127, v7
norescale_3009:
    v_cvt_pk_bf16_f32 v64, v32, v33
    v_cvt_pk_bf16_f32 v65, v34, v35
    v_cvt_pk_bf16_f32 v66, v36, v37
    v_cvt_pk_bf16_f32 v67, v38, v39
    v_cvt_pk_bf16_f32 v68, v40, v41
    v_cvt_pk_bf16_f32 v69, v42, v43
    v_cvt_pk_bf16_f32 v70, v44, v45
    v_cvt_pk_bf16_f32 v71, v46, v47
    v_cvt_pk_bf16_f32 v72, v48, v49
    v_cvt_pk_bf16_f32 v73, v50, v51
    v_cvt_pk_bf16_f32 v74, v52, v53
    v_cvt_pk_bf16_f32 v75, v54, v55
    v_cvt_pk_bf16_f32 v76, v56, v57
    v_cvt_pk_bf16_f32 v77, v58, v59
    v_cvt_pk_bf16_f32 v78, v60, v61
    v_cvt_pk_bf16_f32 v79, v62, v63
    s_waitcnt lgkmcnt(0)
    v_mfma_f32_32x32x16_bf16 v[112:127], v[88:91], v[64:67], v[112:127]
    v_mfma_f32_32x32x16_bf16 v[112:127], v[92:95], v[68:71], v[112:127]
    v_mfma_f32_32x32x16_bf16 v[112:127], v[96:99], v[72:75], v[112:127]
    v_mfma_f32_32x32x16_bf16 v[112:127], v[100:103], v[76:79], v[112:127]
    s_add_u32 s33, s33, 2048
    s_cmp_lt_u32 s33, 16384
    s_cbranch_scc1 loop_3008
    s_nop 15
    v_mov_b32 v6, v120
    v_mov_b32 v5, v120
    s_nop 1
    v_permlane32_swap_b32 v6, v5
    v_rcp_f32 v6, v6
    v_lshlrev_b32 v13, 10, v3
    v_lshl_add_u32 v13, v12, 3, v13
    v_add_u32 v13, s21, v13
    v_mul_f32 v112, v112, v6
    v_mul_f32 v113, v113, v6
    v_mul_f32 v114, v114, v6
    v_mul_f32 v115, v115, v6
    v_mul_f32 v116, v116, v6
    v_mul_f32 v117, v117, v6
    v_mul_f32 v118, v118, v6
    v_mul_f32 v119, v119, v6
    v_cvt_pk_bf16_f32 v80, v112, v113
    v_cvt_pk_bf16_f32 v81, v114, v115
    buffer_store_dwordx2 v[80:81], v13, s[24:27], 0 offen offset:0
    v_cvt_pk_bf16_f32 v82, v116, v117
    v_cvt_pk_bf16_f32 v83, v118, v119
    buffer_store_dwordx2 v[82:83], v13, s[24:27], 0 offen offset:16
done_3001:
    s_endpgm
.globl outp_kernel
.p2align 8
.type outp_kernel,@function
outp_kernel:
    s_load_dwordx2 s[4:5], s[0:1], 104
    s_load_dwordx2 s[6:7], s[0:1], 88
    s_cmp_ge_u32 s2, 1024
    s_cbranch_scc1 done_4002
    s_cmp_lt_u32 s2, 512
    s_cbranch_scc1 job_4003
    s_cmp_lt_u32 s2, 1024
    s_cbranch_scc1 job_4004
job_4003:
    s_load_dwordx2 s[12:13], s[0:1], 80
    s_waitcnt lgkmcnt(0)
    s_add_u32 s8, s4, 58720256
    s_addc_u32 s9, s5, 0
    s_mov_b32 s10, 16777216
    s_mov_b32 s11, 0x00020000
    s_add_u32 s12, s12, 0
    s_addc_u32 s13, s13, 0
    s_mov_b32 s14, 4194304
    s_mov_b32 s15, 0x00020000
    s_add_u32 s16, s6, 1024
    s_addc_u32 s17, s7, 0
    s_mov_b32 s18, 4193280
    s_mov_b32 s19, 0x00020000
    s_sub_u32 s20, s2, 0
    s_and_b32 s21, s20, 7
    s_lshr_b32 s22, s20, 3
    s_mov_b32 s23, 8192
    s_mov_b32 s24, 1024
    s_mov_b32 s25, 2048
    s_mov_b32 s26, 32
    s_mov_b32 s27, 512
    s_branch body_4001
job_4004:
    s_load_dwordx2 s[12:13], s[0:1], 32
    s_waitcnt lgkmcnt(0)
    s_add_u32 s8, s4, 54525952
    s_addc_u32 s9, s5, 0
    s_mov_b32 s10, 2097152
    s_mov_b32 s11, 0x00020000
    s_add_u32 s12, s12, 0
    s_addc_u32 s13, s13, 0
    s_mov_b32 s14, 524288
    s_mov_b32 s15, 0x00020000
    s_add_u32 s16, s6, 0
    s_addc_u32 s17, s7, 0
    s_mov_b32 s18, 4194304
    s_mov_b32 s19, 0x00020000
    s_sub_u32 s20, s2, 512
    s_and_b32 s21, s20, 7
    s_lshr_b32 s22, s20, 3
    s_mov_b32 s23, 1024
    s_mov_b32 s24, 1024
    s_mov_b32 s25, 2048
    s_mov_b32 s26, 4
    s_mov_b32 s27, 512
    s_branch body_4001
body_4001:
    s_mul_i32 s21, s21, 64
    s_mul_i32 s22, s22, 32
    v_and_b32 v18, 15, v0
    v_lshrrev_b32 v19, 4, v0
    v_add_u32 v20, s22, v19
    v_mul_lo_u32 v20, v20, s23
    v_lshl_add_u32 v1, v18, 4, v20
    s_mul_i32 s28, s23, 8
    v_add_u32 v2, s28, v1
    v_add_u32 v3, s28, v2
    v_add_u32 v4, s28, v3
    s_movk_i32 s28, 272
    v_mul_lo_u32 v13, v19, s28
    v_lshl_add_u32 v13, v18, 4, v13
    v_and_b32 v18, 7, v0
    v_lshrrev_b32 v19, 3, v0
    v_mul_lo_u32 v20, v19, s24
    v_lshl_add_u32 v5, v18, 4, v20
    s_lshl_b32 s28, s21, 1
    v_add_u32 v5, s28, v5
    s_mul_i32 s28, s24, 16
    v_add_u32 v6, s28, v5
    v_add_u32 v7, s28, v6
    v_add_u32 v8, s28, v7
    v_add_u32 v9, s28, v8
    v_add_u32 v10, s28, v9
    v_add_u32 v11, s28, v10
    v_add_u32 v12, s28, v11
    s_movk_i32 s28, 192
    v_mul_lo_u32 v14, v19, s28
    v_lshl_add_u32 v14, v18, 4, v14
    v_add_u32 v14, 8704, v14
    v_lshrrev_b32 v18, 6, v0
    s_nop 1
    v_readfirstlane_b32 s29, v18
    s_and_b32 s30, s29, 1
    s_lshr_b32 s31, s29, 1
    v_and_b32 v18, 63, v0
    v_and_b32 v19, 31, v0
    v_bfe_u32 v20, v0, 5, 1
    s_mul_i32 s32, s31, 32
    v_add_u32 v15, s32, v19
    s_movk_i32 s28, 272
    v_mul_lo_u32 v15, v15, s28
    v_lshl_add_u32 v15, v20, 4, v15
    s_add_u32 s32, s32, s22
    v_add_u32 v17, s32, v19
    v_mul_lo_u32 v17, v17, s25
    v_lshl_add_u32 v17, v20, 3, v17
    s_mul_i32 s33, s30, 32
    s_add_u32 s33, s33, s21
    s_lshl_b32 s34, s33, 1
    v_add_u32 v17, s34, v17
    v_bfe_u32 v19, v0, 2, 2
    v_lshl_add_u32 v19, v20, 3, v19
    s_movk_i32 s28, 192
    v_mul_lo_u32 v16, v19, s28
    v_bfe_u32 v19, v0, 4, 1
    v_lshl_add_u32 v16, v19, 5, v16
    v_and_b32 v19, 3, v0
    v_lshl_add_u32 v16, v19, 3, v16
    s_mul_i32 s34, s30, 64
    s_add_u32 s34, s34, 8704
    v_add_u32 v16, s34, v16
    v_mov_b32 v96, 0
    v_mov_b32 v97, 0
    v_mov_b32 v98, 0
    v_mov_b32 v99, 0
    v_mov_b32 v100, 0
    v_mov_b32 v101, 0
    v_mov_b32 v102, 0
    v_mov_b32 v103, 0
    v_mov_b32 v104, 0
    v_mov_b32 v105, 0
    v_mov_b32 v106, 0
    v_mov_b32 v107, 0
    v_mov_b32 v108, 0
    v_mov_b32 v109, 0
    v_mov_b32 v110, 0
    v_mov_b32 v111, 0
    s_mov_b32 s35, 0
    s_mov_b32 s36, 0
    s_lshl_b32 s37, s24, 7
    s_mov_b32 s38, 33280
    buffer_load_dwordx4 v[40:43], v1, s[8:11], s35 offen
    buffer_load_dwordx4 v[44:47], v2, s[8:11], s35 offen
    buffer_load_dwordx4 v[48:51], v3, s[8:11], s35 offen
    buffer_load_dwordx4 v[52:55], v4, s[8:11], s35 offen
    buffer_load_dwordx4 v[56:59], v5, s[12:15], s36 offen
    buffer_load_dwordx4 v[60:63], v6, s[12:15], s36 offen
    buffer_load_dwordx4 v[64:67], v7, s[12:15], s36 offen
    buffer_load_dwordx4 v[68:71], v8, s[12:15], s36 offen
    buffer_load_dwordx4 v[72:75], v9, s[12:15], s36 offen
    buffer_load_dwordx4 v[76:79], v10, s[12:15], s36 offen
    buffer_load_dwordx4 v[80:83], v11, s[12:15], s36 offen
    buffer_load_dwordx4 v[84:87], v12, s[12:15], s36 offen
    s_add_u32 s35, s35, 256
    s_add_u32 s36, s36, s37
    s_waitcnt vmcnt(0)
    ds_write_b128 v13, v[40:43] offset:0
    ds_write_b128 v13, v[44:47] offset:2176
    ds_write_b128 v13, v[48:51] offset:4352
    ds_write_b128 v13, v[52:55] offset:6528
    ds_write_b128 v14, v[56:59] offset:0
    ds_write_b128 v14, v[60:63] offset:3072
    ds_write_b128 v14, v[64:67] offset:6144
    ds_write_b128 v14, v[68:71] offset:9216
    ds_write_b128 v14, v[72:75] offset:12288
    ds_write_b128 v14, v[76:79] offset:15360
    ds_write_b128 v14, v[80:83] offset:18432
    ds_write_b128 v14, v[84:87] offset:21504
    v_add_u32 v13, s38, v13
    v_add_u32 v14, s38, v14
    s_waitcnt lgkmcnt(0)
    s_barrier
kloop_4005:
    s_cmp_le_u32 s26, 1
    s_cbranch_scc1 nold_4006
    buffer_load_dwordx4 v[40:43], v1, s[8:11], s35 offen
    buffer_load_dwordx4 v[44:47], v2, s[8:11], s35 offen
    buffer_load_dwordx4 v[48:51], v3, s[8:11], s35 offen
    buffer_load_dwordx4 v[52:55], v4, s[8:11], s35 offen
    buffer_load_dwordx4 v[56:59], v5, s[12:15], s36 offen
    buffer_load_dwordx4 v[60:63], v6, s[12:15], s36 offen
    buffer_load_dwordx4 v[64:67], v7, s[12:15], s36 offen
    buffer_load_dwordx4 v[68:71], v8, s[12:15], s36 offen
    buffer_load_dwordx4 v[72:75], v9, s[12:15], s36 offen
    buffer_load_dwordx4 v[76:79], v10, s[12:15], s36 offen
    buffer_load_dwordx4 v[80:83], v11, s[12:15], s36 offen
    buffer_load_dwordx4 v[84:87], v12, s[12:15], s36 offen
    s_add_u32 s35, s35, 256
    s_add_u32 s36, s36, s37
nold_4006:
    ds_read_b128 v[24:27], v15 offset:0
    ds_read_b64_tr_b16 v[32:33], v16 offset:0
    ds_read_b64_tr_b16 v[34:35], v16 offset:768
    ds_read_b128 v[28:31], v15 offset:32
    ds_read_b64_tr_b16 v[36:37], v16 offset:3072
    ds_read_b64_tr_b16 v[38:39], v16 offset:3840
    s_waitcnt lgkmcnt(3)
    v_mfma_f32_32x32x16_bf16 v[96:111], v[32:35], v[24:27], v[96:111]
    ds_read_b128 v[24:27], v15 offset:64
    ds_read_b64_tr_b16 v[32:33], v16 offset:6144
    ds_read_b64_tr_b16 v[34:35], v16 offset:6912
    s_waitcnt lgkmcnt(3)
    v_mfma_f32_32x32x16_bf16 v[96:111], v[36:39], v[28:31], v[96:111]
    ds_read_b128 v[28:31], v15 offset:96
    ds_read_b64_tr_b16 v[36:37], v16 offset:9216
    ds_read_b64_tr_b16 v[38:39], v16 offset:9984
    s_waitcnt lgkmcnt(3)
    v_mfma_f32_32x32x16_bf16 v[96:111], v[32:35], v[24:27], v[96:111]
    ds_read_b128 v[24:27], v15 offset:128
    ds_read_b64_tr_b16 v[32:33], v16 offset:12288
    ds_read_b64_tr_b16 v[34:35], v16 offset:13056
    s_waitcnt lgkmcnt(3)
    v_mfma_f32_32x32x16_bf16 v[96:111], v[36:39], v[28:31], v[96:111]
    ds_read_b128 v[28:31], v15 offset:160
    ds_read_b64_tr_b16 v[36:37], v16 offset:15360
    ds_read_b64_tr_b16 v[38:39], v16 offset:16128
    s_waitcnt lgkmcnt(3)
    v_mfma_f32_32x32x16_bf16 v[96:111], v[32:35], v[24:27], v[96:111]
    ds_read_b128 v[24:27], v15 offset:192
    ds_read_b64_tr_b16 v[32:33], v16 offset:18432
    ds_read_b64_tr_b16 v[34:35], v16 offset:19200
    s_waitcnt lgkmcnt(3)
    v_mfma_f32_32x32x16_bf16 v[96:111], v[36:39], v[28:31], v[96:111]
    ds_read_b128 v[28:31], v15 offset:224
    ds_read_b64_tr_b16 v[36:37], v16 offset:21504
    ds_read_b64_tr_b16 v[38:39], v16 offset:22272
    s_waitcnt lgkmcnt(3)
    v_mfma_f32_32x32x16_bf16 v[96:111], v[32:35], v[24:27], v[96:111]
    s_cmp_le_u32 s26, 1
    s_cbranch_scc1 nowr_4007
    s_waitcnt vmcnt(0)
    ds_write_b128 v13, v[40:43] offset:0
    ds_write_b128 v13, v[44:47] offset:2176
    ds_write_b128 v13, v[48:51] offset:4352
    ds_write_b128 v13, v[52:55] offset:6528
    ds_write_b128 v14, v[56:59] offset:0
    ds_write_b128 v14, v[60:63] offset:3072
    ds_write_b128 v14, v[64:67] offset:6144
    ds_write_b128 v14, v[68:71] offset:9216
    ds_write_b128 v14, v[72:75] offset:12288
    ds_write_b128 v14, v[76:79] offset:15360
    ds_write_b128 v14, v[80:83] offset:18432
    ds_write_b128 v14, v[84:87] offset:21504
nowr_4007:
    s_waitcnt lgkmcnt(0)
    v_mfma_f32_32x32x16_bf16 v[96:111], v[36:39], v[28:31], v[96:111]
    v_add_u32 v15, s38, v15
    v_add_u32 v16, s38, v16
    s_sub_u32 s38, 0, s38
    v_add_u32 v13, s38, v13
    v_add_u32 v14, s38, v14
    s_waitcnt lgkmcnt(0)
    s_barrier
    s_sub_u32 s26, s26, 1
    s_cmp_gt_u32 s26, 0
    s_cbranch_scc1 kloop_4005
    s_nop 15
    s_nop 15
    s_mul_i32 s34, s29, 2560
    v_and_b32 v18, 31, v0
    s_movk_i32 s28, 80
    v_mul_lo_u32 v18, v18, s28
    v_bfe_u32 v19, v0, 5, 1
    v_lshl_add_u32 v18, v19, 3, v18
    v_add_u32 v18, s34, v18
    v_cvt_pk_bf16_f32 v96, v96, v97
    v_cvt_pk_bf16_f32 v97, v98, v99
    ds_write_b64 v18, v[96:97] offset:0
    v_cvt_pk_bf16_f32 v100, v100, v101
    v_cvt_pk_bf16_f32 v101, v102, v103
    ds_write_b64 v18, v[100:101] offset:16
    v_cvt_pk_bf16_f32 v104, v104, v105
    v_cvt_pk_bf16_f32 v105, v106, v107
    ds_write_b64 v18, v[104:105] offset:32
    v_cvt_pk_bf16_f32 v108, v108, v109
    v_cvt_pk_bf16_f32 v109, v110, v111
    ds_write_b64 v18, v[108:109] offset:48
    v_and_b32 v19, 63, v0
    v_lshrrev_b32 v20, 2, v19
    v_and_b32 v19, 3, v19
    v_mul_lo_u32 v18, v20, s28
    v_lshl_add_u32 v18, v19, 4, v18
    v_add_u32 v18, s34, v18
    v_add_u32 v20, s32, v20
    v_mul_lo_u32 v17, v20, s25
    v_lshl_add_u32 v17, v19, 4, v17
    s_lshl_b32 s39, s33, 1
    v_add_u32 v17, s39, v17
    v_lshl_add_u32 v19, v19, 3, s33
    v_cmp_gt_u32 vcc, s27, v19
    s_waitcnt lgkmcnt(0)
    ds_read_b128 v[96:99], v18 offset:0
    ds_read_b128 v[100:103], v18 offset:1280
    s_and_saveexec_b64 s[40:41], vcc
    s_mul_i32 s34, s25, 16
    s_mov_b32 s39, 0
    s_waitcnt lgkmcnt(1)
    buffer_store_dwordx4 v[96:99], v17, s[16:19], s39 offen
    s_add_u32 s39, s39, s34
    s_waitcnt lgkmcnt(0)
    buffer_store_dwordx4 v[100:103], v17, s[16:19], s39 offen
    s_add_u32 s39, s39, s34
    s_mov_b64 exec, s[40:41]
done_4002:
    s_endpgm
.section .rodata,"a"
.p2align 6
.amdhsa_kernel proj_kernel
  .amdhsa_next_free_vgpr 240
  .amdhsa_next_free_sgpr 48
  .amdhsa_accum_offset 240
  .amdhsa_group_segment_fixed_size 0
  .amdhsa_kernarg_size 112
  .amdhsa_user_sgpr_count 2
  .amdhsa_user_sgpr_kernarg_segment_ptr 1
  .amdhsa_system_sgpr_workgroup_id_x 1
.end_amdhsa_kernel
.p2align 6
.amdhsa_kernel attnb_kernel
  .amdhsa_next_free_vgpr 224
  .amdhsa_next_free_sgpr 48
  .amdhsa_accum_offset 224
  .amdhsa_group_segment_fixed_size 0
  .amdhsa_kernarg_size 112
  .amdhsa_user_sgpr_count 2
  .amdhsa_user_sgpr_kernarg_segment_ptr 1
  .amdhsa_system_sgpr_workgroup_id_x 1
.end_amdhsa_kernel
.p2align 6
.amdhsa_kernel outp_kernel
  .amdhsa_next_free_vgpr 112
  .amdhsa_next_free_sgpr 48
  .amdhsa_accum_offset 112
  .amdhsa_group_segment_fixed_size 0
  .amdhsa_kernarg_size 112
  .amdhsa_user_sgpr_count 2
  .amdhsa_user_sgpr_kernarg_segment_ptr 1
  .amdhsa_system_sgpr_workgroup_id_x 1
.end_amdhsa_kernel
```
